```python
import torch

def _softmax(x, axis=-1):
    return torch.softmax(x, dim=axis)
def _gelu(x):
    return torch.nn.functional.gelu(x, approximate="tanh")
def _silu(x):
    return torch.nn.functional.silu(x)
def _sigmoid(x):
    return torch.sigmoid(x)
def _layernorm(x, axis=-1, eps=1e-5):
    m = x.mean(dim=axis, keepdim=True)
    v = x.var(dim=axis, keepdim=True, unbiased=False)
    return (x - m) / torch.sqrt(v + eps)
def _scatter_add(tgt, idx, src, axis=0):
    return tgt.clone().index_add_(axis, idx, src)
def _segment_sum(src, seg, n):
    out = torch.zeros((n,) + src.shape[1:], dtype=src.dtype)
    return out.index_add_(0, seg, src)
def _pad(x, pw):
    flat = tuple(v for pair in reversed(pw) for v in pair)
    return torch.nn.functional.pad(x, flat)

kernel_name = 'gated_mix__spectral_gfnet__glu_gated_reglu__prompt'

def setup_inputs():

    _w = (lambda a: (lambda t: t.to(torch.bfloat16) if t.is_floating_point() else t)(torch.as_tensor(a)))
    def _A_setup():
        B, S, D = 1, 2048, 512
        Df = D // 2 + 1
        return {
            "x": _w((lambda *s: torch.randn(*s, dtype=torch.bfloat16) * 0.05)(B, S, D)),
            "w_r": _w((lambda *s: torch.randn(*s, dtype=torch.bfloat16) * 0.05)(S, Df) * 0.02),
            "w_i": _w((lambda *s: torch.randn(*s, dtype=torch.bfloat16) * 0.05)(S, Df) * 0.02),
        }
    _A_in = _A_setup()

    def _B_setup():
        B, S, D, F = 1, 2048, 512, 1792
        return {
            "x": _w((lambda *s: torch.randn(*s, dtype=torch.bfloat16) * 0.05)(B, S, D)),
            "W_gate": _w((lambda *s: torch.randn(*s, dtype=torch.bfloat16) * 0.2)(D, F) * (2.0 / D) ** 0.5),
            "W_up": _w((lambda *s: torch.randn(*s, dtype=torch.bfloat16) * 0.2)(D, F) * (2.0 / D) ** 0.5),
            "W_down": _w((lambda *s: torch.randn(*s, dtype=torch.bfloat16) * 0.2)(F, D) * (1.0 / F) ** 0.5),
        }
    _B_in = _B_setup()

    return {
        "A_x": _A_in["x"],
        "A_w_r": _A_in["w_r"],
        "A_w_i": _A_in["w_i"],
        "B_x": _B_in["x"],
        "B_W_gate": _B_in["W_gate"],
        "B_W_up": _B_in["W_up"],
        "B_W_down": _B_in["W_down"],
        "gate_w": _w((lambda *s: torch.randn(*s, dtype=torch.bfloat16) * 0.05)(512) * 16.0),
    }

def reference(A_x, A_w_r, A_w_i, B_x, B_W_gate, B_W_up, B_W_down, gate_w):
    def _A_ref(x, w_r, w_i):
        B, S, D = x.shape
        X = (lambda x, axes=(-2,-1): torch.fft.rfft2(x.float(), dim=axes))(x, axes=(-2, -1))
        W = w_r + 1j * w_i
        X = X * W
        y = (lambda x, s, axes=(-2,-1): torch.fft.irfft2(x, s=s, dim=axes).to(torch.bfloat16))(X, (S, D), axes=(-2, -1))
        return y

    def _B_ref(x, W_gate, W_up, W_down):
        gate = torch.einsum("bsd,df->bsf", x, W_gate)
        up = torch.einsum("bsd,df->bsf", x, W_up)
        gate = gate * (lambda x, dt: x.to(dt))(gate > 0, gate.dtype)
        h = gate * up
        return torch.einsum("bsf,fd->bsd", h, W_down)

    x = A_x
    g = _sigmoid((x * gate_w).sum(-1, keepdims=True))
    a = _A_ref(x, A_w_r, A_w_i)
    b = _B_ref(x, B_W_gate, B_W_up, B_W_down)
    return g * a + (1 - g) * b
```

```asm
; @launch grid=(256,1,1) block=(512,1,1) lds=156736
.amdgcn_target "amdgcn-amd-amdhsa--gfx950"
.text
.p2align 12, 0
.space 256
.globl gated_mix__spectral_gfnet__glu_gated_reglu__prompt_kernel
.p2align 8
.type gated_mix__spectral_gfnet__glu_gated_reglu__prompt_kernel,@function
gated_mix__spectral_gfnet__glu_gated_reglu__prompt_kernel:
  s_cmp_ge_u32 s2, 256
  s_cbranch_scc1 L_end
  s_load_dwordx2 s[8:9], s[0:1], 0
  s_load_dwordx2 s[12:13], s[0:1], 32
  s_load_dwordx2 s[16:17], s[0:1], 40
  s_load_dwordx2 s[20:21], s[0:1], 80
  s_cmp_ge_u32 s2, 64
  s_cbranch_scc1 L_nocpf
  s_getpc_b64 s[4:5]
L_pc:
  v_cmp_gt_u32 vcc, 64, v0
  s_lshr_b32 s55, s2, 3
  s_mul_i32 s55, s55, 64
  v_add_lshl_u32 v1, s55, v0, 7
  s_cbranch_vccz L_nocpf
  v_min_u32 v1, L_end-L_pc+1536, v1
  global_load_dword v191, v1, s[4:5]
L_nocpf:
  s_mov_b32 s10, 2097152
  s_mov_b32 s11, 0x20000
  s_mov_b32 s14, 1835008
  s_mov_b32 s15, 0x20000
  s_mov_b32 s18, 1835008
  s_mov_b32 s19, 0x20000
  s_mov_b32 s22, 268435456
  s_mov_b32 s23, 0x20000
  v_lshrrev_b32 v1, 6, v0
  v_and_b32 v0, 63, v0
  v_readfirstlane_b32 s48, v1
  s_and_b32 s53, s2, 7
  s_and_b32 s52, s2, 1
  s_lshr_b32 s51, s2, 5
  s_xor_b32 s84, s51, 4
  s_bfe_u32 s55, s2, 0x20003
  s_and_b32 s50, s2, 6
  s_lshl_b32 s50, s50, 1
  s_add_u32 s50, s50, s55
  s_lshl_b32 s54, s50, 1
  s_add_u32 s54, s54, s52
  s_add_u32 s79, s2, 32
  s_and_b32 s79, s79, 255
  s_and_b32 s49, s48, 3
  s_lshr_b32 s55, s48, 2
  s_lshl_b32 s55, s55, 3
  s_add_u32 s55, s55, s51
  s_cmp_lt_u32 s55, 7
  s_cbranch_scc1 L_comp
  s_cmp_eq_u32 s55, 7
  s_cbranch_scc1 L_dftm
  s_cmp_eq_u32 s55, 15
  s_cbranch_scc1 L_dfth
  s_setprio 1
  v_lshrrev_b32 v1, 3, v0
  v_lshlrev_b32 v1, 10, v1
  v_lshrrev_b32 v2, 4, v0
  v_and_b32 v12, 7, v0
  v_xor_b32 v12, v12, v2
  v_lshl_add_u32 v1, v12, 4, v1
  s_lshl_b32 s55, s54, 1
  s_xor_b32 s55, s55, s49
  s_xor_b32 s55, s55, 2
  s_lshl_b32 s55, s55, 15
  v_add_u32 v4, s55, v1
  v_xor_b32 v1, 64, v4
  v_add_u32 v5, 7168, v1
  v_add_u32 v6, 14336, v4
  v_add_u32 v7, 21504, v1
  s_lshl_b32 s58, s49, 12
  v_mul_u32_u24 v1, 3584, v2
  v_lshlrev_b32 v2, 2, v2
  v_and_b32 v12, 15, v0
  v_xor_b32 v2, v2, v12
  v_lshl_add_u32 v1, v2, 4, v1
  s_mul_i32 s55, s52, 7
  s_add_u32 s55, s55, s51
  s_lshl_b32 s55, s55, 8
  s_mul_i32 s56, s49, 28672
  s_add_u32 s55, s55, s56
  s_and_b32 s56, s49, 1
  s_lshl_b32 s56, s56, 5
  v_xor_b32 v1, s56, v1
  v_add_u32 v8, s55, v1
  v_add_u32 v9, 13312, v8
  v_add_u32 v10, 114688, v8
  v_add_u32 v11, 114688, v9
  s_lshl_b32 s57, s49, 11
  s_add_u32 s64, s50, s51
  s_and_b32 s64, s64, 1
  s_bfe_u32 s55, s2, 0x10001
  s_mul_i32 s55, s55, 4
  s_xor_b32 s64, s64, s55
  s_waitcnt lgkmcnt(0)
  s_xor_b32 s61, s64, 0
  s_add_u32 m0, s58, 0
  s_lshl_b32 s59, s61, 7
  buffer_load_dwordx4 v4, s[8:11], s59 offen offset:0  lds
  buffer_load_dwordx4 v5, s[8:11], s59 offen offset:1024  lds
  buffer_load_dwordx4 v6, s[8:11], s59 offen offset:2048  lds
  buffer_load_dwordx4 v7, s[8:11], s59 offen offset:3072  lds
  s_add_u32 m0, s57, 16384
  s_mul_i32 s60, s61, 229376
  buffer_load_dwordx4 v8, s[12:15], s60 offen offset:0 lds
  buffer_load_dwordx4 v9, s[12:15], s60 offen offset:1024 lds
  s_add_u32 m0, s57, 32768
  s_nop 0
  buffer_load_dwordx4 v8, s[16:19], s60 offen offset:0 lds
  buffer_load_dwordx4 v9, s[16:19], s60 offen offset:1024 lds
  s_add_u32 m0, s57, 24576
  s_nop 0
  buffer_load_dwordx4 v10, s[12:15], s60 offen offset:0 lds
  buffer_load_dwordx4 v11, s[12:15], s60 offen offset:1024 lds
  s_add_u32 m0, s57, 40960
  s_nop 0
  buffer_load_dwordx4 v10, s[16:19], s60 offen offset:0 lds
  buffer_load_dwordx4 v11, s[16:19], s60 offen offset:1024 lds
  s_load_dwordx2 s[24:25], s[0:1], 48
  s_mov_b32 s26, 1835008
  s_mov_b32 s27, 0x20000
  s_load_dwordx2 s[28:29], s[0:1], 64
  s_mov_b32 s30, 2097152
  s_mov_b32 s31, 0x20000
  s_load_dwordx2 s[32:33], s[0:1], 72
  s_mov_b32 s34, 256
  s_mov_b32 s35, 0x20000
  s_load_dwordx2 s[36:37], s[0:1], 8
  s_mov_b32 s38, 1052672
  s_mov_b32 s39, 0x20000
  s_load_dwordx2 s[40:41], s[0:1], 16
  s_mov_b32 s42, 1052672
  s_mov_b32 s43, 0x20000
  s_add_u32 s6, s20, 17891328
  s_addc_u32 s7, s21, 0
  s_mov_b32 s81, 1
  s_mov_b32 s82, 156160
  s_mov_b32 s83, 147456
  v_and_b32 v12, 15, v0
  v_lshrrev_b32 v13, 4, v0
  s_lshl_b32 s89, s49, 4
  v_add_u32 v248, s89, v12
  v_cvt_f32_u32 v248, v248
  v_mul_f32 v232, 0x3c800000, v248
  v_mul_f32 v233, 0x3a000000, v248
  v_cvt_f32_u32 v249, v13
  v_mul_f32 v249, 4.0, v249
  v_mul_f32 v234, v249, v232
  v_mul_f32 v235, v249, v233
  v_fmamk_f32 v236, v232, 0x00000000, v234
  v_cos_f32 v237, v236
  v_sin_f32 v238, v236
  v_fmamk_f32 v239, v232, 0x3f800000, v234
  v_cos_f32 v240, v239
  v_sin_f32 v241, v239
  v_cvt_pk_bf16_f32 v80, v237, v238
  v_cvt_pk_bf16_f32 v96, -v238, v237
  v_fmamk_f32 v236, v232, 0x40000000, v234
  v_cos_f32 v237, v236
  v_sin_f32 v238, v236
  v_cvt_pk_bf16_f32 v81, v240, v241
  v_cvt_pk_bf16_f32 v97, -v241, v240
  v_fmamk_f32 v239, v232, 0x40400000, v234
  v_cos_f32 v240, v239
  v_sin_f32 v241, v239
  v_cvt_pk_bf16_f32 v82, v237, v238
  v_cvt_pk_bf16_f32 v98, -v238, v237
  v_fmamk_f32 v236, v232, 0x41800000, v234
  v_cos_f32 v237, v236
  v_sin_f32 v238, v236
  v_cvt_pk_bf16_f32 v83, v240, v241
  v_cvt_pk_bf16_f32 v99, -v241, v240
  v_fmamk_f32 v239, v232, 0x41880000, v234
  v_cos_f32 v240, v239
  v_sin_f32 v241, v239
  v_cvt_pk_bf16_f32 v84, v237, v238
  v_cvt_pk_bf16_f32 v100, -v238, v237
  v_fmamk_f32 v236, v232, 0x41900000, v234
  v_cos_f32 v237, v236
  v_sin_f32 v238, v236
  v_cvt_pk_bf16_f32 v85, v240, v241
  v_cvt_pk_bf16_f32 v101, -v241, v240
  v_fmamk_f32 v239, v232, 0x41980000, v234
  v_cos_f32 v240, v239
  v_sin_f32 v241, v239
  v_cvt_pk_bf16_f32 v86, v237, v238
  v_cvt_pk_bf16_f32 v102, -v238, v237
  v_fmamk_f32 v236, v232, 0x42000000, v234
  v_cos_f32 v237, v236
  v_sin_f32 v238, v236
  v_cvt_pk_bf16_f32 v87, v240, v241
  v_cvt_pk_bf16_f32 v103, -v241, v240
  v_fmamk_f32 v239, v232, 0x42040000, v234
  v_cos_f32 v240, v239
  v_sin_f32 v241, v239
  v_cvt_pk_bf16_f32 v88, v237, v238
  v_cvt_pk_bf16_f32 v104, -v238, v237
  v_fmamk_f32 v236, v232, 0x42080000, v234
  v_cos_f32 v237, v236
  v_sin_f32 v238, v236
  v_cvt_pk_bf16_f32 v89, v240, v241
  v_cvt_pk_bf16_f32 v105, -v241, v240
  v_fmamk_f32 v239, v232, 0x420c0000, v234
  v_cos_f32 v240, v239
  v_sin_f32 v241, v239
  v_cvt_pk_bf16_f32 v90, v237, v238
  v_cvt_pk_bf16_f32 v106, -v238, v237
  v_fmamk_f32 v236, v232, 0x42400000, v234
  v_cos_f32 v237, v236
  v_sin_f32 v238, v236
  v_cvt_pk_bf16_f32 v91, v240, v241
  v_cvt_pk_bf16_f32 v107, -v241, v240
  v_fmamk_f32 v239, v232, 0x42440000, v234
  v_cos_f32 v240, v239
  v_sin_f32 v241, v239
  v_cvt_pk_bf16_f32 v92, v237, v238
  v_cvt_pk_bf16_f32 v108, -v238, v237
  v_fmamk_f32 v236, v232, 0x42480000, v234
  v_cos_f32 v237, v236
  v_sin_f32 v238, v236
  v_cvt_pk_bf16_f32 v93, v240, v241
  v_cvt_pk_bf16_f32 v109, -v241, v240
  v_fmamk_f32 v239, v232, 0x424c0000, v234
  v_cos_f32 v240, v239
  v_sin_f32 v241, v239
  v_cvt_pk_bf16_f32 v94, v237, v238
  v_cvt_pk_bf16_f32 v110, -v238, v237
  v_fmamk_f32 v236, v233, 0x00000000, v235
  v_cvt_pk_bf16_f32 v95, v240, v241
  v_cvt_pk_bf16_f32 v111, -v241, v240
  v_cos_f32 v136, v236
  v_sin_f32 v144, v236
  v_fmamk_f32 v236, v233, 0x3f800000, v235
  v_cos_f32 v137, v236
  v_sin_f32 v145, v236
  v_fmamk_f32 v236, v233, 0x40000000, v235
  v_cos_f32 v138, v236
  v_sin_f32 v146, v236
  v_fmamk_f32 v236, v233, 0x40400000, v235
  v_cos_f32 v139, v236
  v_sin_f32 v147, v236
  v_fmamk_f32 v236, v233, 0x41800000, v235
  v_cos_f32 v140, v236
  v_sin_f32 v148, v236
  v_fmamk_f32 v236, v233, 0x41880000, v235
  v_cos_f32 v141, v236
  v_sin_f32 v149, v236
  v_fmamk_f32 v236, v233, 0x41900000, v235
  v_cos_f32 v142, v236
  s_xor_b32 s61, s64, 1
  s_add_u32 m0, s58, 49152
  s_lshl_b32 s59, s61, 7
  buffer_load_dwordx4 v4, s[8:11], s59 offen offset:0  lds
  v_sin_f32 v150, v236
  v_fmamk_f32 v236, v233, 0x41980000, v235
  v_cos_f32 v143, v236
  v_sin_f32 v151, v236
  v_cvt_f32_u32 v248, v12
  v_mul_f32 v232, 0x3d000000, v248
  v_mul_f32 v234, v249, v232
  buffer_load_dwordx4 v5, s[8:11], s59 offen offset:1024  lds
  v_and_b32 v248, 1, v0
  v_mul_u32_u24 v248, 0x8000, v248
  v_lshl_or_b32 v248, v248, 16, v248
  s_mov_b32 s89, 0x80008000
  v_fmamk_f32 v236, v232, 0x00000000, v234
  v_cos_f32 v216, v236
  v_sin_f32 v224, v236
  buffer_load_dwordx4 v6, s[8:11], s59 offen offset:2048  lds
  v_fmamk_f32 v236, v232, 0x3f800000, v234
  v_cos_f32 v217, v236
  v_sin_f32 v225, v236
  v_fmamk_f32 v236, v232, 0x40000000, v234
  v_cos_f32 v218, v236
  v_sin_f32 v226, v236
  v_fmamk_f32 v236, v232, 0x40400000, v234
  buffer_load_dwordx4 v7, s[8:11], s59 offen offset:3072  lds
  v_cos_f32 v219, v236
  v_sin_f32 v227, v236
  v_cvt_pk_bf16_f32 v112, v216, v217
  v_cvt_pk_bf16_f32 v113, v218, v219
  v_xor_b32 v114, v248, v112
  v_xor_b32 v115, v248, v113
  v_xor_b32 v116, 0x80000000, v112
  s_add_u32 m0, s57, 65536
  s_mul_i32 s60, s61, 229376
  buffer_load_dwordx4 v8, s[12:15], s60 offen offset:0 lds
  v_xor_b32 v117, 0x80000000, v113
  v_xor_b32 v118, 0x80000000, v114
  v_xor_b32 v119, 0x80000000, v115
  v_cvt_pk_bf16_f32 v120, v224, v225
  v_cvt_pk_bf16_f32 v121, v226, v227
  v_xor_b32 v122, v248, v120
  v_xor_b32 v123, v248, v121
  buffer_load_dwordx4 v9, s[12:15], s60 offen offset:1024 lds
  v_xor_b32 v124, 0x80000000, v120
  v_xor_b32 v125, 0x80000000, v121
  v_xor_b32 v126, 0x80000000, v122
  v_xor_b32 v127, 0x80000000, v123
  v_xor_b32 v128, s89, v120
  v_xor_b32 v129, s89, v121
  v_xor_b32 v130, s89, v122
  s_add_u32 m0, s57, 81920
  s_waitcnt vmcnt(10)
  s_barrier
  buffer_load_dwordx4 v8, s[16:19], s60 offen offset:0 lds
  v_xor_b32 v131, s89, v123
  v_xor_b32 v132, s89, v124
  v_xor_b32 v133, s89, v125
  v_xor_b32 v134, s89, v126
  v_xor_b32 v135, s89, v127
  v_mul_u32_u24 v248, 1088, v13
  v_lshl_add_u32 v248, v12, 2, v248
  buffer_load_dwordx4 v9, s[16:19], s60 offen offset:1024 lds
  s_lshl_b32 s89, s49, 6
  s_add_u32 s90, s89, s83
  v_add_u32 v14, s90, v248
  v_mul_u32_u24 v248, 272, v12
  v_lshl_add_u32 v248, v13, 4, v248
  v_add_u32 v15, s83, v248
  v_lshlrev_b32 v248, 4, v12
  s_add_u32 m0, s57, 73728
  s_nop 0
  buffer_load_dwordx4 v10, s[12:15], s60 offen offset:0 lds
  v_lshl_add_u32 v184, v13, 9, v248
  v_add_u32 v185, s83, v184
  v_lshlrev_b32 v248, 8, v13
  v_lshl_add_u32 v248, v12, 2, v248
  v_add_lshl_u32 v186, s89, v248, 2
  s_mul_i32 s66, s79, 8448
  s_add_u32 s67, s66, 11534336
  buffer_load_dwordx4 v11, s[12:15], s60 offen offset:1024 lds
  s_add_u32 s68, s67, 4096
  s_lshl_b32 s69, s49, 11
  s_add_u32 s69, s69, s66
  s_add_u32 s69, s69, 14680064
  s_lshr_b32 s70, s79, 6
  s_lshl_b32 s70, s70, 2
  s_and_b32 s72, s79, 3
  s_add_u32 m0, s57, 90112
  s_nop 0
  buffer_load_dwordx4 v10, s[16:19], s60 offen offset:0 lds
  s_add_u32 s70, s70, s72
  s_lshl_b32 s70, s70, 8
  s_add_u32 s70, s70, 32768
  s_mov_b32 s95, 0
  s_add_u32 s66, s66, 8388608
  buffer_load_dwordx4 v11, s[16:19], s60 offen offset:1024 lds
  s_waitcnt lgkmcnt(0)
  s_waitcnt vmcnt(12)
  s_barrier
  s_xor_b32 s61, s64, 2
  s_add_u32 m0, s58, 98304
  s_lshl_b32 s59, s61, 7
  buffer_load_dwordx4 v4, s[8:11], s59 offen offset:0  lds
  s_lshl_b32 s74, s51, 3
  s_add_u32 s74, s74, s53
  buffer_load_dwordx4 v5, s[8:11], s59 offen offset:1024  lds
  s_lshl_b32 s55, s51, 2
  s_add_u32 s55, s55, s49
  buffer_load_dwordx4 v6, s[8:11], s59 offen offset:2048  lds
  s_lshl_b32 s55, s55, 3
  s_add_u32 s55, s55, s53
  buffer_load_dwordx4 v7, s[8:11], s59 offen offset:3072  lds
  s_mul_i32 s55, s55, 4112
  s_bfe_u32 s75, s2, 0x20003
  s_add_u32 m0, s57, 114688
  s_mul_i32 s60, s61, 229376
  buffer_load_dwordx4 v8, s[12:15], s60 offen offset:0 lds
  s_lshl_b32 s56, s75, 7
  s_add_u32 s55, s55, s56
  buffer_load_dwordx4 v9, s[12:15], s60 offen offset:1024 lds
  v_lshrrev_b32 v1, 3, v0
  v_mul_u32_u24 v1, 514, v1
  s_add_u32 m0, s57, 131072
  s_nop 0
  buffer_load_dwordx4 v8, s[16:19], s60 offen offset:0 lds
  v_and_b32 v2, 7, v0
  v_lshl_add_u32 v1, v2, 4, v1
  buffer_load_dwordx4 v9, s[16:19], s60 offen offset:1024 lds
  s_lshl_b32 s56, s49, 10
  s_add_u32 m0, s57, 122880
  s_nop 0
  buffer_load_dwordx4 v10, s[12:15], s60 offen offset:0 lds
  buffer_load_dwordx4 v11, s[12:15], s60 offen offset:1024 lds
  s_add_u32 m0, s57, 139264
  s_nop 0
  buffer_load_dwordx4 v10, s[16:19], s60 offen offset:0 lds
  buffer_load_dwordx4 v11, s[16:19], s60 offen offset:1024 lds
  s_add_u32 m0, s56, 147456
  s_nop 0
  buffer_load_dwordx4 v1, s[36:39], s55 offen nt lds
  s_add_u32 m0, s56, 151552
  s_nop 0
  buffer_load_dwordx4 v1, s[40:43], s55 offen nt lds
  s_waitcnt vmcnt(14)
  s_barrier
  s_xor_b32 s61, s64, 3
  s_add_u32 m0, s58, 0
  s_lshl_b32 s59, s61, 7
  buffer_load_dwordx4 v4, s[8:11], s59 offen offset:0  lds
  buffer_load_dwordx4 v5, s[8:11], s59 offen offset:1024  lds
  buffer_load_dwordx4 v6, s[8:11], s59 offen offset:2048  lds
  buffer_load_dwordx4 v7, s[8:11], s59 offen offset:3072  lds
  s_add_u32 m0, s57, 16384
  s_mul_i32 s60, s61, 229376
  buffer_load_dwordx4 v8, s[12:15], s60 offen offset:0 lds
  buffer_load_dwordx4 v9, s[12:15], s60 offen offset:1024 lds
  s_add_u32 m0, s57, 32768
  s_nop 0
  buffer_load_dwordx4 v8, s[16:19], s60 offen offset:0 lds
  buffer_load_dwordx4 v9, s[16:19], s60 offen offset:1024 lds
  s_add_u32 m0, s57, 24576
  s_nop 0
  buffer_load_dwordx4 v10, s[12:15], s60 offen offset:0 lds
  buffer_load_dwordx4 v11, s[12:15], s60 offen offset:1024 lds
  s_add_u32 m0, s57, 40960
  s_nop 0
  buffer_load_dwordx4 v10, s[16:19], s60 offen offset:0 lds
  buffer_load_dwordx4 v11, s[16:19], s60 offen offset:1024 lds
  s_cmp_lg_u32 s49, 0
  s_cselect_b32 s55, 0x1000, 0
  v_lshl_add_u32 v187, v0, 8, s55
  buffer_load_dword v188, v187, s[32:35], 0 offen sc1
  s_waitcnt vmcnt(15)
  s_barrier
  s_xor_b32 s61, s64, 4
  s_add_u32 m0, s58, 49152
  s_lshl_b32 s59, s61, 7
  buffer_load_dwordx4 v4, s[8:11], s59 offen offset:0  lds
  buffer_load_dwordx4 v5, s[8:11], s59 offen offset:1024  lds
  buffer_load_dwordx4 v6, s[8:11], s59 offen offset:2048  lds
  buffer_load_dwordx4 v7, s[8:11], s59 offen offset:3072  lds
  s_add_u32 m0, s57, 65536
  s_mul_i32 s60, s61, 229376
  buffer_load_dwordx4 v8, s[12:15], s60 offen offset:0 lds
  buffer_load_dwordx4 v9, s[12:15], s60 offen offset:1024 lds
  s_add_u32 m0, s57, 81920
  s_nop 0
  buffer_load_dwordx4 v8, s[16:19], s60 offen offset:0 lds
  buffer_load_dwordx4 v9, s[16:19], s60 offen offset:1024 lds
  s_add_u32 m0, s57, 73728
  s_nop 0
  buffer_load_dwordx4 v10, s[12:15], s60 offen offset:0 lds
  buffer_load_dwordx4 v11, s[12:15], s60 offen offset:1024 lds
  s_add_u32 m0, s57, 90112
  s_nop 0
  buffer_load_dwordx4 v10, s[16:19], s60 offen offset:0 lds
  buffer_load_dwordx4 v11, s[16:19], s60 offen offset:1024 lds
  s_waitcnt vmcnt(13)
  s_barrier
  s_xor_b32 s61, s64, 5
  s_add_u32 m0, s58, 98304
  s_lshl_b32 s59, s61, 7
  buffer_load_dwordx4 v4, s[8:11], s59 offen offset:0  lds
  v_and_b32 v1, 7, v0
  v_lshrrev_b32 v2, 3, v0
  v_lshlrev_b32 v168, 7, v1
  buffer_load_dwordx4 v5, s[8:11], s59 offen offset:1024  lds
  v_lshl_add_u32 v168, v2, 4, v168
  s_lshl_b32 s55, s49, 2
  s_add_u32 s55, s55, 147456
  buffer_load_dwordx4 v6, s[8:11], s59 offen offset:2048  lds
  v_add_u32 v168, s55, v168
  ds_read_b32 v152, v168 offset:0
  ds_read_b32 v153, v168 offset:1024
  buffer_load_dwordx4 v7, s[8:11], s59 offen offset:3072  lds
  ds_read_b32 v154, v168 offset:2048
  ds_read_b32 v155, v168 offset:3072
  ds_read_b32 v156, v168 offset:4096
  s_add_u32 m0, s57, 114688
  s_mul_i32 s60, s61, 229376
  buffer_load_dwordx4 v8, s[12:15], s60 offen offset:0 lds
  ds_read_b32 v157, v168 offset:5120
  ds_read_b32 v158, v168 offset:6144
  ds_read_b32 v159, v168 offset:7168
  buffer_load_dwordx4 v9, s[12:15], s60 offen offset:1024 lds
  v_mul_u32_u24 v2, 67584, v2
  v_lshl_add_u32 v1, v1, 4, v2
  s_lshl_b32 s55, s75, 5
  s_add_u32 m0, s57, 131072
  s_nop 0
  buffer_load_dwordx4 v8, s[16:19], s60 offen offset:0 lds
  s_add_u32 s55, s55, s49
  s_mul_i32 s55, s55, 16896
  s_lshl_b32 s56, s74, 7
  buffer_load_dwordx4 v9, s[16:19], s60 offen offset:1024 lds
  s_add_u32 s55, s55, s56
  s_add_u32 s55, s55, 11534336
  s_add_u32 s56, s55, 8448
  s_add_u32 m0, s57, 122880
  s_nop 0
  buffer_load_dwordx4 v10, s[12:15], s60 offen offset:0 lds
  s_mov_b32 s76, 0x05040100
  s_mov_b32 s77, 0x07060302
  s_waitcnt lgkmcnt(0)
  buffer_load_dwordx4 v11, s[12:15], s60 offen offset:1024 lds
  v_perm_b32 v160, v156, v152, s76
  v_perm_b32 v161, v157, v153, s76
  v_perm_b32 v162, v158, v154, s76
  s_add_u32 m0, s57, 139264
  s_nop 0
  buffer_load_dwordx4 v10, s[16:19], s60 offen offset:0 lds
  v_perm_b32 v163, v159, v155, s76
  v_perm_b32 v164, v156, v152, s77
  v_perm_b32 v165, v157, v153, s77
  buffer_load_dwordx4 v11, s[16:19], s60 offen offset:1024 lds
  v_perm_b32 v166, v158, v154, s77
  v_perm_b32 v167, v159, v155, s77
  buffer_store_dwordx4 v[160:163], v1, s[20:23], s55 offen sc1
  buffer_store_dwordx4 v[164:167], v1, s[20:23], s56 offen sc1
  s_waitcnt vmcnt(14)
  s_barrier
  s_xor_b32 s61, s64, 6
  s_add_u32 m0, s58, 0
  s_lshl_b32 s59, s61, 7
  buffer_load_dwordx4 v4, s[8:11], s59 offen offset:0  lds
  buffer_load_dwordx4 v5, s[8:11], s59 offen offset:1024  lds
  buffer_load_dwordx4 v6, s[8:11], s59 offen offset:2048  lds
  buffer_load_dwordx4 v7, s[8:11], s59 offen offset:3072  lds
  s_add_u32 m0, s57, 16384
  s_mul_i32 s60, s61, 229376
  buffer_load_dwordx4 v8, s[12:15], s60 offen offset:0 lds
  buffer_load_dwordx4 v9, s[12:15], s60 offen offset:1024 lds
  s_add_u32 m0, s57, 32768
  s_nop 0
  buffer_load_dwordx4 v8, s[16:19], s60 offen offset:0 lds
  buffer_load_dwordx4 v9, s[16:19], s60 offen offset:1024 lds
  s_add_u32 m0, s57, 24576
  s_nop 0
  buffer_load_dwordx4 v10, s[12:15], s60 offen offset:0 lds
  buffer_load_dwordx4 v11, s[12:15], s60 offen offset:1024 lds
  s_add_u32 m0, s57, 40960
  s_nop 0
  buffer_load_dwordx4 v10, s[16:19], s60 offen offset:0 lds
  buffer_load_dwordx4 v11, s[16:19], s60 offen offset:1024 lds
  v_lshlrev_b32 v1, 7, v0
  s_lshl_b32 s56, s2, 2
  s_add_u32 s56, s56, s49
  s_lshl_b32 s56, s56, 11
  s_mov_b64 exec, 0xffff
  buffer_load_dword v189, v1, s[24:27], s56 offen
  s_mov_b64 exec, -1
  s_waitcnt vmcnt(13)
  s_cmp_lg_u32 s49, 0
  s_cbranch_scc1 L_ini1
  s_mov_b32 exec_lo, 0x1
  s_mov_b32 exec_hi, 0x0
  s_mov_b32 s63, 0x80000
  v_cmp_gt_u32 vcc, 7, v188
  s_nop 0
  s_cbranch_vccz PX0
P0:
  buffer_load_dword v1, v187, s[32:35], 0 offen sc1
  s_sub_u32 s63, s63, 1
  s_cbranch_scc1 PX0
  s_waitcnt vmcnt(0)
  v_cmp_gt_u32 vcc, 7, v1
  s_nop 0
  s_cbranch_vccz PX0
  s_mov_b64 exec, vcc
  s_sleep 2
  s_branch P0
PX0:
  s_mov_b64 exec, -1
L_ini1:
  s_barrier
  s_cmp_lg_u32 s49, 0
  s_cbranch_scc1 L_ini2
  s_lshl_b32 s55, s75, 10
  s_add_u32 s55, s55, 32768
  s_atomic_add s81, s[6:7], s55
  s_atomic_add s81, s[6:7], s55 offset:0x100
  s_atomic_add s81, s[6:7], s55 offset:0x200
  s_atomic_add s81, s[6:7], s55 offset:0x300
L_ini2:
  s_xor_b32 s61, s64, 7
  s_add_u32 m0, s58, 49152
  s_lshl_b32 s59, s61, 7
  buffer_load_dwordx4 v4, s[8:11], s59 offen offset:0  lds
  buffer_load_dwordx4 v5, s[8:11], s59 offen offset:1024  lds
  buffer_load_dwordx4 v6, s[8:11], s59 offen offset:2048  lds
  buffer_load_dwordx4 v7, s[8:11], s59 offen offset:3072  lds
  s_add_u32 m0, s57, 65536
  s_mul_i32 s60, s61, 229376
  buffer_load_dwordx4 v8, s[12:15], s60 offen offset:0 lds
  buffer_load_dwordx4 v9, s[12:15], s60 offen offset:1024 lds
  s_add_u32 m0, s57, 81920
  s_nop 0
  buffer_load_dwordx4 v8, s[16:19], s60 offen offset:0 lds
  buffer_load_dwordx4 v9, s[16:19], s60 offen offset:1024 lds
  s_add_u32 m0, s57, 73728
  s_nop 0
  buffer_load_dwordx4 v10, s[12:15], s60 offen offset:0 lds
  buffer_load_dwordx4 v11, s[12:15], s60 offen offset:1024 lds
  s_add_u32 m0, s57, 90112
  s_nop 0
  buffer_load_dwordx4 v10, s[16:19], s60 offen offset:0 lds
  buffer_load_dwordx4 v11, s[16:19], s60 offen offset:1024 lds
  v_lshrrev_b32 v1, 3, v0
  v_lshlrev_b32 v1, 10, v1
  v_lshrrev_b32 v2, 4, v0
  v_lshlrev_b32 v2, 1, v2
  v_and_b32 v4, 7, v0
  v_xor_b32 v2, v2, v4
  v_lshl_add_u32 v1, v2, 4, v1
  s_lshl_b32 s55, s84, 7
  s_lshl_b32 s56, s49, 15
  s_add_u32 s55, s55, s56
  s_mul_i32 s56, s52, 917504
  s_add_u32 s55, s55, s56
  v_add_u32 v4, s55, v1
  v_add_u32 v5, 7168, v4
  v_add_u32 v6, 14336, v4
  v_add_u32 v7, 21504, v4
  s_and_b32 s85, s50, 0
  s_mul_i32 s85, s85, 0
  s_add_u32 s85, s85, s51
  s_sub_u32 s55, s85, 7
  s_cselect_b32 s85, s85, s55
  s_sub_u32 s55, s85, 7
  s_cselect_b32 s85, s85, s55
  s_mul_i32 s87, s49, 12288
  s_add_u32 s87, s87, 98304
  s_lshr_b32 s88, s49, 1
  s_mul_i32 s88, s88, 4
  s_add_u32 s88, s88, s49
  s_add_u32 s88, s88, 2
  s_lshl_b32 s88, s88, 13
  s_waitcnt vmcnt(13)
  s_barrier
  s_add_u32 m0, s87, 0
  s_add_u32 s86, s85, 0
  s_sub_u32 s92, s86, 7
  s_cselect_b32 s86, s86, s92
  s_lshl_b32 s86, s86, 17
  buffer_load_dwordx4 v4, s[24:27], s86 offen offset:0 lds
  buffer_load_dwordx4 v5, s[24:27], s86 offen offset:1024 lds
  buffer_load_dwordx4 v6, s[24:27], s86 offen offset:2048 lds
  buffer_load_dwordx4 v7, s[24:27], s86 offen offset:3072 lds
  s_add_u32 m0, s87, 4096
  s_add_u32 s86, s85, 1
  s_sub_u32 s92, s86, 7
  s_cselect_b32 s86, s86, s92
  s_lshl_b32 s86, s86, 17
  buffer_load_dwordx4 v4, s[24:27], s86 offen offset:0 lds
  buffer_load_dwordx4 v5, s[24:27], s86 offen offset:1024 lds
  buffer_load_dwordx4 v6, s[24:27], s86 offen offset:2048 lds
  buffer_load_dwordx4 v7, s[24:27], s86 offen offset:3072 lds
  s_waitcnt vmcnt(8)
  s_barrier
  s_cmp_lg_u32 s49, 0
  s_cbranch_scc1 L_noapx
  s_mov_b32 s95, 0
  s_atomic_add s95, s[6:7], s70 glc
L_noapx:
  s_add_u32 m0, s87, 8192
  s_add_u32 s86, s85, 2
  s_sub_u32 s92, s86, 7
  s_cselect_b32 s86, s86, s92
  s_lshl_b32 s86, s86, 17
  buffer_load_dwordx4 v4, s[24:27], s86 offen offset:0 lds
  buffer_load_dwordx4 v5, s[24:27], s86 offen offset:1024 lds
  buffer_load_dwordx4 v6, s[24:27], s86 offen offset:2048 lds
  buffer_load_dwordx4 v7, s[24:27], s86 offen offset:3072 lds
L_fft:
  s_cmp_lg_u32 s49, 0
  s_cbranch_scc1 L_nopoll
  s_waitcnt lgkmcnt(0)
  s_cmp_ge_u32 s95, 80
  s_cbranch_scc1 SX1
  s_mov_b32 s63, 0x80000
SP1:
  s_mov_b32 s62, 0
  s_atomic_add s62, s[6:7], s70 glc
  s_waitcnt lgkmcnt(0)
  s_cmp_ge_u32 s62, 80
  s_cbranch_scc1 SX1
  s_sub_u32 s63, s63, 1
  s_cbranch_scc1 SX1
  s_sleep 2
  s_branch SP1
SX1:
  s_cmp_eq_u32 s79, 0
  s_cbranch_scc1 R_p256
R_p256_b:
  v_mov_b32 v2, s82
  v_mov_b32 v1, 1
  s_mov_b64 exec, 1
  ds_add_u32 v2, v1 offset:8
  s_mov_b64 exec, -1
L_nopoll:
  v_mov_b32 v2, s82
  s_mov_b32 s63, 0x800000
  s_mov_b64 exec, 1
W3:
  ds_read_b32 v1, v2 offset:8
  s_sub_u32 s63, s63, 1
  s_cbranch_scc1 WX3
  s_waitcnt lgkmcnt(0)
  v_cmp_gt_u32 vcc, 1, v1
  s_nop 0
  s_cbranch_vccz WX3
  s_sleep 1
  s_branch W3
WX3:
  s_mov_b64 exec, -1
  s_setprio 2
  s_lshl_b32 s55, s49, 11
  s_add_u32 m0, s83, s55
  s_add_u32 s66, s66, s55
  v_lshlrev_b32 v1, 4, v0
  buffer_load_dwordx4 v1, s[20:23], s66 offen offset:0 sc1 lds
  buffer_load_dwordx4 v1, s[20:23], s66 offen offset:1024 sc1 lds
  buffer_load_dwordx4 v[192:195], v186, s[20:23], s67 offen sc1
  buffer_load_dwordx4 v[196:199], v186, s[20:23], s68 offen sc1
  s_cmp_eq_u32 s51, 7
  s_cbranch_scc1 R_c7
R_c7_b:
  v_mov_b32 v2, s82
  v_mov_b32 v1, 1
  s_mov_b64 exec, 1
  s_waitcnt vmcnt(4)
  ds_add_u32 v2, v1 offset:28
  s_waitcnt vmcnt(0)
  ds_add_rtn_u32 v1, v2, v1
  s_mov_b32 s63, 0x800000
  s_waitcnt lgkmcnt(0)
  v_cmp_gt_u32 vcc, 3, v1
  s_nop 0
  s_cbranch_vccz WX5
W5:
  ds_read_b32 v1, v2
  s_sub_u32 s63, s63, 1
  s_cbranch_scc1 WX5
  s_waitcnt lgkmcnt(0)
  v_cmp_gt_u32 vcc, 4, v1
  s_nop 0
  s_cbranch_vccnz W5
WX5:
  s_mov_b64 exec, -1
  ds_read_b128 v[152:155], v185 offset:0
  ds_read_b128 v[156:159], v185 offset:2048
  ds_read_b128 v[160:163], v185 offset:4096
  ds_read_b128 v[164:167], v185 offset:6144
  ds_read_b128 v[168:171], v185 offset:256
  ds_read_b128 v[172:175], v185 offset:2304
  ds_read_b128 v[176:179], v185 offset:4352
  ds_read_b128 v[180:183], v185 offset:6400
  s_cmp_eq_u32 s79, 0
  s_cbranch_scc1 R_s2
R_s2_b:
  s_waitcnt lgkmcnt(7)
  v_mfma_f32_16x16x32_bf16 v[216:219], v[152:155], v[80:83], 0
  v_lshlrev_b32 v200, 16, v192
  v_and_b32 v208, 0xffff0000, v192
  v_mfma_f32_16x16x32_bf16 v[224:227], v[152:155], v[96:99], 0
  v_lshlrev_b32 v201, 16, v193
  v_and_b32 v209, 0xffff0000, v193
  s_waitcnt lgkmcnt(6)
  v_mfma_f32_16x16x32_bf16 v[216:219], v[156:159], v[84:87], v[216:219]
  v_lshlrev_b32 v202, 16, v194
  v_and_b32 v210, 0xffff0000, v194
  v_mfma_f32_16x16x32_bf16 v[224:227], v[156:159], v[100:103], v[224:227]
  v_lshlrev_b32 v203, 16, v195
  v_and_b32 v211, 0xffff0000, v195
  s_waitcnt lgkmcnt(5)
  v_mfma_f32_16x16x32_bf16 v[216:219], v[160:163], v[88:91], v[216:219]
  v_lshlrev_b32 v204, 16, v196
  v_and_b32 v212, 0xffff0000, v196
  v_mfma_f32_16x16x32_bf16 v[224:227], v[160:163], v[104:107], v[224:227]
  v_lshlrev_b32 v205, 16, v197
  v_and_b32 v213, 0xffff0000, v197
  s_waitcnt lgkmcnt(4)
  v_mfma_f32_16x16x32_bf16 v[216:219], v[164:167], v[92:95], v[216:219]
  v_lshlrev_b32 v206, 16, v198
  v_and_b32 v214, 0xffff0000, v198
  v_mfma_f32_16x16x32_bf16 v[224:227], v[164:167], v[108:111], v[224:227]
  v_lshlrev_b32 v207, 16, v199
  v_and_b32 v215, 0xffff0000, v199
  s_waitcnt lgkmcnt(3)
  v_mfma_f32_16x16x32_bf16 v[220:223], v[168:171], v[80:83], 0
  v_mfma_f32_16x16x32_bf16 v[228:231], v[168:171], v[96:99], 0
  s_waitcnt lgkmcnt(2)
  v_mfma_f32_16x16x32_bf16 v[220:223], v[172:175], v[84:87], v[220:223]
  v_mfma_f32_16x16x32_bf16 v[228:231], v[172:175], v[100:103], v[228:231]
  s_waitcnt lgkmcnt(1)
  v_mfma_f32_16x16x32_bf16 v[220:223], v[176:179], v[88:91], v[220:223]
  v_mul_f32 v232, v216, v136
  v_mul_f32 v240, v224, v136
  v_mfma_f32_16x16x32_bf16 v[228:231], v[176:179], v[104:107], v[228:231]
  v_fma_f32 v232, v224, v144, v232
  v_fma_f32 v240, -v216, v144, v240
  s_waitcnt lgkmcnt(0)
  v_mfma_f32_16x16x32_bf16 v[220:223], v[180:183], v[92:95], v[220:223]
  v_mul_f32 v233, v217, v137
  v_mul_f32 v241, v225, v137
  v_mfma_f32_16x16x32_bf16 v[228:231], v[180:183], v[108:111], v[228:231]
  v_fma_f32 v233, v225, v145, v233
  v_fma_f32 v241, -v217, v145, v241
  s_mov_b64 exec, 1
  v_mov_b32 v1, 1
  ds_add_u32 v2, v1
  s_mov_b64 exec, -1
  v_cvt_pk_bf16_f32 v248, v232, v233
  v_cvt_pk_bf16_f32 v252, v240, v241
  v_mul_f32 v234, v218, v138
  v_mul_f32 v242, v226, v138
  v_fma_f32 v234, v226, v146, v234
  v_fma_f32 v242, -v218, v146, v242
  v_mul_f32 v235, v219, v139
  v_mul_f32 v243, v227, v139
  v_fma_f32 v235, v227, v147, v235
  v_fma_f32 v243, -v219, v147, v243
  v_cvt_pk_bf16_f32 v249, v234, v235
  v_cvt_pk_bf16_f32 v253, v242, v243
  v_mul_f32 v236, v220, v140
  v_mul_f32 v244, v228, v140
  v_fma_f32 v236, v228, v148, v236
  v_fma_f32 v244, -v220, v148, v244
  v_mul_f32 v237, v221, v141
  v_mul_f32 v245, v229, v141
  v_fma_f32 v237, v229, v149, v237
  v_fma_f32 v245, -v221, v149, v245
  v_cvt_pk_bf16_f32 v250, v236, v237
  v_cvt_pk_bf16_f32 v254, v244, v245
  v_mul_f32 v238, v222, v142
  v_mul_f32 v246, v230, v142
  v_fma_f32 v238, v230, v150, v238
  v_fma_f32 v246, -v222, v150, v246
  v_mul_f32 v239, v223, v143
  v_mul_f32 v247, v231, v143
  v_fma_f32 v239, v231, v151, v239
  v_fma_f32 v247, -v223, v151, v247
  v_cvt_pk_bf16_f32 v251, v238, v239
  v_cvt_pk_bf16_f32 v255, v246, v247
  s_nop 0
  v_mfma_f32_16x16x32_bf16 v[216:219], v[112:115], v[248:251], 0
  v_mfma_f32_16x16x32_bf16 v[224:227], v[112:115], v[252:255], 0
  v_mfma_f32_16x16x32_bf16 v[216:219], v[120:123], v[252:255], v[216:219]
  v_mfma_f32_16x16x32_bf16 v[224:227], v[128:131], v[248:251], v[224:227]
  v_mfma_f32_16x16x32_bf16 v[220:223], v[116:119], v[248:251], 0
  v_mfma_f32_16x16x32_bf16 v[228:231], v[116:119], v[252:255], 0
  v_mfma_f32_16x16x32_bf16 v[220:223], v[124:127], v[252:255], v[220:223]
  v_mfma_f32_16x16x32_bf16 v[228:231], v[132:135], v[248:251], v[228:231]
  s_cmp_eq_u32 s79, 0
  s_cbranch_scc1 R_s3
  s_nop 0
  v_mul_f32 v232, v216, v200
  v_mul_f32 v240, v224, v200
  v_fma_f32 v232, -v224, v208, v232
  v_fma_f32 v240, v216, v208, v240
  v_mul_f32 v233, v217, v201
  v_mul_f32 v241, v225, v201
  v_fma_f32 v233, -v225, v209, v233
  v_fma_f32 v241, v217, v209, v241
  v_cvt_pk_bf16_f32 v248, v232, v233
  v_cvt_pk_bf16_f32 v252, v240, v241
  v_mul_f32 v234, v218, v202
  v_mul_f32 v242, v226, v202
  v_fma_f32 v234, -v226, v210, v234
  v_fma_f32 v242, v218, v210, v242
  v_mul_f32 v235, v219, v203
  v_mul_f32 v243, v227, v203
  v_fma_f32 v235, -v227, v211, v235
  v_fma_f32 v243, v219, v211, v243
  v_cvt_pk_bf16_f32 v249, v234, v235
  v_cvt_pk_bf16_f32 v253, v242, v243
  v_mul_f32 v236, v220, v204
  v_mul_f32 v244, v228, v204
  v_fma_f32 v236, -v228, v212, v236
  v_fma_f32 v244, v220, v212, v244
  v_mul_f32 v237, v221, v205
  v_mul_f32 v245, v229, v205
  v_fma_f32 v237, -v229, v213, v237
  v_fma_f32 v245, v221, v213, v245
  v_cvt_pk_bf16_f32 v250, v236, v237
  v_cvt_pk_bf16_f32 v254, v244, v245
  v_mul_f32 v238, v222, v206
  v_mul_f32 v246, v230, v206
  v_fma_f32 v238, -v230, v214, v238
  v_fma_f32 v246, v222, v214, v246
  v_mul_f32 v239, v223, v207
  v_mul_f32 v247, v231, v207
  v_fma_f32 v239, -v231, v215, v239
  v_fma_f32 v247, v223, v215, v247
  v_cvt_pk_bf16_f32 v251, v238, v239
  v_cvt_pk_bf16_f32 v255, v246, v247
L_s3:
  v_mov_b32 v2, s82
  ds_read_b32 v1, v2
  v_mfma_f32_16x16x32_bf16 v[216:219], v[112:115], v[248:251], 0
  v_mfma_f32_16x16x32_bf16 v[224:227], v[112:115], v[252:255], 0
  v_mfma_f32_16x16x32_bf16 v[216:219], v[128:131], v[252:255], v[216:219]
  v_mfma_f32_16x16x32_bf16 v[224:227], v[120:123], v[248:251], v[224:227]
  v_mfma_f32_16x16x32_bf16 v[220:223], v[116:119], v[248:251], 0
  v_mfma_f32_16x16x32_bf16 v[228:231], v[116:119], v[252:255], 0
  v_mfma_f32_16x16x32_bf16 v[220:223], v[132:135], v[252:255], v[220:223]
  v_mfma_f32_16x16x32_bf16 v[228:231], v[124:127], v[248:251], v[228:231]
  s_waitcnt lgkmcnt(0)
  v_cmp_gt_u32 vcc, 8, v1
  s_nop 0
  s_cbranch_vccz L_zfree
  v_mov_b32 v2, s82
  s_mov_b32 s63, 0x800000
  s_mov_b64 exec, 1
W8:
  ds_read_b32 v1, v2 offset:0
  s_sub_u32 s63, s63, 1
  s_cbranch_scc1 WX8
  s_waitcnt lgkmcnt(0)
  v_cmp_gt_u32 vcc, 8, v1
  s_nop 0
  s_cbranch_vccnz W8
WX8:
  s_mov_b64 exec, -1
L_zfree:
  v_mul_f32 v232, v216, v136
  v_mul_f32 v240, v224, v136
  v_fma_f32 v232, -v224, v144, v232
  v_fma_f32 v240, v216, v144, v240
  v_mul_f32 v233, v217, v137
  v_mul_f32 v241, v225, v137
  v_fma_f32 v233, -v225, v145, v233
  v_fma_f32 v241, v217, v145, v241
  v_cvt_pk_bf16_f32 v248, v232, -v240
  ds_write_b32 v14, v248 offset:0
  v_cvt_pk_bf16_f32 v249, v233, -v241
  ds_write_b32 v14, v249 offset:272
  v_mul_f32 v234, v218, v138
  v_mul_f32 v242, v226, v138
  v_fma_f32 v234, -v226, v146, v234
  v_fma_f32 v242, v218, v146, v242
  v_mul_f32 v235, v219, v139
  v_mul_f32 v243, v227, v139
  v_fma_f32 v235, -v227, v147, v235
  v_fma_f32 v243, v219, v147, v243
  v_cvt_pk_bf16_f32 v250, v234, -v242
  ds_write_b32 v14, v250 offset:544
  v_cvt_pk_bf16_f32 v251, v235, -v243
  ds_write_b32 v14, v251 offset:816
  v_mul_f32 v236, v220, v140
  v_mul_f32 v244, v228, v140
  v_fma_f32 v236, -v228, v148, v236
  v_fma_f32 v244, v220, v148, v244
  v_mul_f32 v237, v221, v141
  v_mul_f32 v245, v229, v141
  v_fma_f32 v237, -v229, v149, v237
  v_fma_f32 v245, v221, v149, v245
  v_cvt_pk_bf16_f32 v252, v236, -v244
  ds_write_b32 v14, v252 offset:4352
  v_cvt_pk_bf16_f32 v253, v237, -v245
  ds_write_b32 v14, v253 offset:4624
  v_mul_f32 v238, v222, v142
  v_mul_f32 v246, v230, v142
  v_fma_f32 v238, -v230, v150, v238
  v_fma_f32 v246, v222, v150, v246
  v_mul_f32 v239, v223, v143
  v_mul_f32 v247, v231, v143
  v_fma_f32 v239, -v231, v151, v239
  v_fma_f32 v247, v223, v151, v247
  v_cvt_pk_bf16_f32 v254, v238, -v246
  ds_write_b32 v14, v254 offset:4896
  v_cvt_pk_bf16_f32 v255, v239, -v247
  ds_write_b32 v14, v255 offset:5168
  v_mov_b32 v1, 1
  s_mov_b64 exec, 1
  ds_add_rtn_u32 v1, v2, v1
  s_mov_b32 s63, 0x800000
  s_waitcnt lgkmcnt(0)
  v_cmp_gt_u32 vcc, 11, v1
  s_nop 0
  s_cbranch_vccz WX9
W9:
  ds_read_b32 v1, v2
  s_sub_u32 s63, s63, 1
  s_cbranch_scc1 WX9
  s_waitcnt lgkmcnt(0)
  v_cmp_gt_u32 vcc, 12, v1
  s_nop 0
  s_cbranch_vccnz W9
WX9:
  s_mov_b64 exec, -1
  ds_read_b128 v[152:155], v15 offset:0
  ds_read_b128 v[156:159], v15 offset:64
  ds_read_b128 v[160:163], v15 offset:128
  ds_read_b128 v[164:167], v15 offset:192
  ds_read_b128 v[168:171], v15 offset:4352
  ds_read_b128 v[172:175], v15 offset:4416
  ds_read_b128 v[176:179], v15 offset:4480
  ds_read_b128 v[180:183], v15 offset:4544
  s_waitcnt lgkmcnt(7)
  v_mfma_f32_16x16x32_bf16 v[216:219], v[80:83], v[152:155], 0
  v_mfma_f32_16x16x32_bf16 v[224:227], v[96:99], v[152:155], 0
  s_waitcnt lgkmcnt(6)
  v_mfma_f32_16x16x32_bf16 v[216:219], v[84:87], v[156:159], v[216:219]
  v_mfma_f32_16x16x32_bf16 v[224:227], v[100:103], v[156:159], v[224:227]
  s_waitcnt lgkmcnt(5)
  v_mfma_f32_16x16x32_bf16 v[216:219], v[88:91], v[160:163], v[216:219]
  v_mfma_f32_16x16x32_bf16 v[224:227], v[104:107], v[160:163], v[224:227]
  s_waitcnt lgkmcnt(4)
  v_mfma_f32_16x16x32_bf16 v[216:219], v[92:95], v[164:167], v[216:219]
  v_mfma_f32_16x16x32_bf16 v[224:227], v[108:111], v[164:167], v[224:227]
  s_waitcnt lgkmcnt(3)
  v_mfma_f32_16x16x32_bf16 v[220:223], v[80:83], v[168:171], 0
  v_mfma_f32_16x16x32_bf16 v[228:231], v[96:99], v[168:171], 0
  s_waitcnt lgkmcnt(2)
  v_mfma_f32_16x16x32_bf16 v[220:223], v[84:87], v[172:175], v[220:223]
  v_mfma_f32_16x16x32_bf16 v[228:231], v[100:103], v[172:175], v[228:231]
  s_waitcnt lgkmcnt(1)
  v_mfma_f32_16x16x32_bf16 v[220:223], v[88:91], v[176:179], v[220:223]
  v_mfma_f32_16x16x32_bf16 v[228:231], v[104:107], v[176:179], v[228:231]
  s_waitcnt lgkmcnt(0)
  v_mfma_f32_16x16x32_bf16 v[220:223], v[92:95], v[180:183], v[220:223]
  v_mfma_f32_16x16x32_bf16 v[228:231], v[108:111], v[180:183], v[228:231]
  v_cvt_pk_bf16_f32 v248, v216, -v224
  v_cvt_pk_bf16_f32 v250, v217, -v225
  v_cvt_pk_bf16_f32 v252, v218, -v226
  v_cvt_pk_bf16_f32 v254, v219, -v227
  s_nop 7
  v_cvt_pk_bf16_f32 v249, v220, -v228
  v_cvt_pk_bf16_f32 v251, v221, -v229
  v_cvt_pk_bf16_f32 v253, v222, -v230
  v_cvt_pk_bf16_f32 v255, v223, -v231
  buffer_store_dwordx4 v[248:251], v184, s[20:23], s69 offen offset:0 sc1
  buffer_store_dwordx4 v[252:255], v184, s[20:23], s69 offen offset:256 sc1
  s_setprio 0
  s_lshl_b32 s89, s49, 4
  v_lshl_add_u32 v187, v13, 2, s89
  v_cvt_f32_u32 v187, v187
  v_and_b32 v232, 1, v0
  v_mul_u32_u24 v188, 0x202, v232
  v_lshl_or_b32 v188, v188, 16, v188
  v_xor_b32 v188, 0x03020100, v188
  v_lshlrev_b32 v233, 4, v232
  v_mov_b32 v191, 0x80000000
  v_lshrrev_b32 v191, v233, v191
  v_bfe_u32 v233, v0, 1, 1
  v_xor_b32 v232, v232, v233
  v_lshlrev_b32 v232, 31, v232
  v_lshl_or_b32 v189, v233, 15, v232
  s_lshl_b32 s89, s84, 6
  s_add_u32 s89, s89, 0
  v_add_u32 v232, s89, v12
  v_cvt_f32_u32 v232, v232
  v_mul_f32 v232, 0x3b000000, v232
  v_mul_f32 v233, v187, v232
  v_add_f32 v234, v233, v232
  v_add_f32 v235, v234, v232
  v_add_f32 v236, v235, v232
  v_cos_f32 v237, v233
  v_sin_f32 v241, v233
  v_cos_f32 v238, v234
  v_sin_f32 v242, v234
  v_cos_f32 v239, v235
  v_sin_f32 v243, v235
  v_cos_f32 v240, v236
  v_sin_f32 v244, v236
  v_cvt_pk_bf16_f32 v16, v237, -v241
  v_cvt_pk_bf16_f32 v17, v238, -v242
  v_cvt_pk_bf16_f32 v18, v239, -v243
  v_cvt_pk_bf16_f32 v19, v240, -v244
  v_perm_b32 v32, v16, v16, v188
  v_xor_b32 v64, v191, v16
  v_perm_b32 v33, v17, v17, v188
  v_xor_b32 v65, v191, v17
  v_perm_b32 v34, v18, v18, v188
  v_xor_b32 v66, v191, v18
  v_perm_b32 v35, v19, v19, v188
  v_xor_b32 v67, v191, v19
  v_xor_b32 v32, v189, v32
  v_xor_b32 v33, v189, v33
  v_xor_b32 v34, v189, v34
  v_xor_b32 v35, v189, v35
  v_xor_b32 v48, v191, v32
  v_xor_b32 v49, v191, v33
  v_xor_b32 v50, v191, v34
  v_xor_b32 v51, v191, v35
  s_lshl_b32 s89, s84, 6
  s_add_u32 s89, s89, 16
  v_add_u32 v232, s89, v12
  v_cvt_f32_u32 v232, v232
  v_mul_f32 v232, 0x3b000000, v232
  v_mul_f32 v233, v187, v232
  v_add_f32 v234, v233, v232
  v_add_f32 v235, v234, v232
  v_add_f32 v236, v235, v232
  v_cos_f32 v237, v233
  v_sin_f32 v241, v233
  v_cos_f32 v238, v234
  v_sin_f32 v242, v234
  v_cos_f32 v239, v235
  v_sin_f32 v243, v235
  v_cos_f32 v240, v236
  v_sin_f32 v244, v236
  v_cvt_pk_bf16_f32 v20, v237, -v241
  v_cvt_pk_bf16_f32 v21, v238, -v242
  v_cvt_pk_bf16_f32 v22, v239, -v243
  v_cvt_pk_bf16_f32 v23, v240, -v244
  v_perm_b32 v36, v20, v20, v188
  v_xor_b32 v68, v191, v20
  v_perm_b32 v37, v21, v21, v188
  v_xor_b32 v69, v191, v21
  v_perm_b32 v38, v22, v22, v188
  v_xor_b32 v70, v191, v22
  v_perm_b32 v39, v23, v23, v188
  v_xor_b32 v71, v191, v23
  v_xor_b32 v36, v189, v36
  v_xor_b32 v37, v189, v37
  v_xor_b32 v38, v189, v38
  v_xor_b32 v39, v189, v39
  v_xor_b32 v52, v191, v36
  v_xor_b32 v53, v191, v37
  v_xor_b32 v54, v191, v38
  v_xor_b32 v55, v191, v39
  s_lshl_b32 s89, s84, 6
  s_add_u32 s89, s89, 32
  v_add_u32 v232, s89, v12
  v_cvt_f32_u32 v232, v232
  v_mul_f32 v232, 0x3b000000, v232
  v_mul_f32 v233, v187, v232
  v_add_f32 v234, v233, v232
  v_add_f32 v235, v234, v232
  v_add_f32 v236, v235, v232
  v_cos_f32 v237, v233
  v_sin_f32 v241, v233
  v_cos_f32 v238, v234
  v_sin_f32 v242, v234
  v_cos_f32 v239, v235
  v_sin_f32 v243, v235
  v_cos_f32 v240, v236
  v_sin_f32 v244, v236
  v_cvt_pk_bf16_f32 v24, v237, -v241
  v_cvt_pk_bf16_f32 v25, v238, -v242
  v_cvt_pk_bf16_f32 v26, v239, -v243
  v_cvt_pk_bf16_f32 v27, v240, -v244
  v_perm_b32 v40, v24, v24, v188
  v_xor_b32 v72, v191, v24
  v_perm_b32 v41, v25, v25, v188
  v_xor_b32 v73, v191, v25
  v_perm_b32 v42, v26, v26, v188
  v_xor_b32 v74, v191, v26
  v_perm_b32 v43, v27, v27, v188
  v_xor_b32 v75, v191, v27
  v_xor_b32 v40, v189, v40
  v_xor_b32 v41, v189, v41
  v_xor_b32 v42, v189, v42
  v_xor_b32 v43, v189, v43
  v_xor_b32 v56, v191, v40
  v_xor_b32 v57, v191, v41
  v_xor_b32 v58, v191, v42
  v_xor_b32 v59, v191, v43
  s_lshl_b32 s89, s84, 6
  s_add_u32 s89, s89, 48
  v_add_u32 v232, s89, v12
  v_cvt_f32_u32 v232, v232
  v_mul_f32 v232, 0x3b000000, v232
  v_mul_f32 v233, v187, v232
  v_add_f32 v234, v233, v232
  v_add_f32 v235, v234, v232
  v_add_f32 v236, v235, v232
  v_cos_f32 v237, v233
  v_sin_f32 v241, v233
  v_cos_f32 v238, v234
  v_sin_f32 v242, v234
  v_cos_f32 v239, v235
  v_sin_f32 v243, v235
  v_cos_f32 v240, v236
  v_sin_f32 v244, v236
  v_cvt_pk_bf16_f32 v28, v237, -v241
  v_cvt_pk_bf16_f32 v29, v238, -v242
  v_cvt_pk_bf16_f32 v30, v239, -v243
  v_cvt_pk_bf16_f32 v31, v240, -v244
  v_perm_b32 v44, v28, v28, v188
  v_xor_b32 v76, v191, v28
  v_perm_b32 v45, v29, v29, v188
  v_xor_b32 v77, v191, v29
  v_perm_b32 v46, v30, v30, v188
  v_xor_b32 v78, v191, v30
  v_perm_b32 v47, v31, v31, v188
  v_xor_b32 v79, v191, v31
  v_xor_b32 v44, v189, v44
  v_xor_b32 v45, v189, v45
  v_xor_b32 v46, v189, v46
  v_xor_b32 v47, v189, v47
  v_xor_b32 v60, v191, v44
  v_xor_b32 v61, v191, v45
  v_xor_b32 v62, v191, v46
  v_xor_b32 v63, v191, v47
  s_waitcnt vmcnt(0)
  v_mov_b32 v2, s82
  v_mov_b32 v1, 1
  s_mov_b64 exec, 1
  ds_add_rtn_u32 v1, v2, v1 offset:4
  s_waitcnt lgkmcnt(0)
  v_cmp_ne_u32 vcc, 3, v1
  s_mov_b64 exec, -1
  s_cbranch_vccnz LS10
  s_mov_b32 s55, 0xb000
  s_cmp_eq_u32 s79, 0
  s_cbranch_scc1 L_go
  s_and_b32 s55, s2, 3
  s_cselect_b32 s56, 63, 62
  s_lshl_b32 s55, s55, 8
  s_mov_b32 s62, 1
  s_atomic_add s62, s[6:7], s55 offset:0x9400 glc
  s_waitcnt lgkmcnt(0)
  s_mov_b32 s55, 0xa000
  s_cmp_lg_u32 s62, s56
  s_cbranch_scc1 L_nogo
L_go:
  s_atomic_add s81, s[6:7], s55
  s_atomic_add s81, s[6:7], s55 offset:0x100
  s_atomic_add s81, s[6:7], s55 offset:0x200
  s_atomic_add s81, s[6:7], s55 offset:0x300
  s_atomic_add s81, s[6:7], s55 offset:0x400
  s_atomic_add s81, s[6:7], s55 offset:0x500
  s_atomic_add s81, s[6:7], s55 offset:0x600
  s_atomic_add s81, s[6:7], s55 offset:0x700
  s_atomic_add s81, s[6:7], s55 offset:0x800
  s_atomic_add s81, s[6:7], s55 offset:0x900
  s_atomic_add s81, s[6:7], s55 offset:0xa00
  s_atomic_add s81, s[6:7], s55 offset:0xb00
  s_atomic_add s81, s[6:7], s55 offset:0xc00
  s_atomic_add s81, s[6:7], s55 offset:0xd00
  s_atomic_add s81, s[6:7], s55 offset:0xe00
  s_atomic_add s81, s[6:7], s55 offset:0xf00
L_nogo:
LS10:
  v_or_b32 v5, s49, v13
  v_lshlrev_b32 v1, 31, v0
  v_or_b32 v1, 0x3e003e00, v1
  v_cmp_eq_u32 vcc, 0, v5
  v_mul_u32_u24 v2, 33792, v13
  v_lshl_add_u32 v4, v12, 4, v2
  v_sub_u32 v2, 101376, v2
  v_lshl_add_u32 v158, v12, 4, v2
  v_add_u32 v159, 540672, v158
  v_cndmask_b32 v159, v159, v158, vcc
  v_cvt_f32_u32 v2, v12
  v_mul_f32 v2, 0x3e000000, v2
  v_cos_f32 v232, v2
  v_sin_f32 v233, v2
  s_mul_i32 s57, s49, 135168
  s_lshl_b32 s71, s57, 1
  v_cvt_pk_bf16_f32 v2, v232, -v233
  v_xor_b32 v232, v191, v2
  v_cndmask_b32 v16, v16, v1, vcc
  v_cndmask_b32 v48, v48, v2, vcc
  v_cndmask_b32 v64, v64, v232, vcc
  v_cndmask_b32 v20, v20, v1, vcc
  v_cndmask_b32 v52, v52, v2, vcc
  v_cndmask_b32 v68, v68, v232, vcc
  v_cndmask_b32 v24, v24, v1, vcc
  v_cndmask_b32 v56, v56, v2, vcc
  v_cndmask_b32 v72, v72, v232, vcc
  v_cndmask_b32 v28, v28, v1, vcc
  v_cndmask_b32 v60, v60, v2, vcc
  v_cndmask_b32 v76, v76, v232, vcc
  s_lshl_b32 s55, s54, 8
  s_add_u32 s57, s57, s55
  s_add_u32 s57, s57, 14680064
  s_sub_u32 s71, s57, s71
  s_and_b32 s55, s2, 15
  s_lshl_b32 s55, s55, 8
  s_add_u32 s55, s55, 40960
  s_lshr_b32 s88, s49, 1
  s_lshl_b32 s88, s88, 2
  s_add_u32 s88, s88, s49
  s_lshl_b32 s88, s88, 13
  v_and_b32 v1, 15, v0
  v_lshrrev_b32 v2, 5, v0
  v_and_b32 v5, 7, v0
  v_xor_b32 v6, v2, v5
  v_lshlrev_b32 v6, 4, v6
  v_lshl_add_u32 v6, v1, 7, v6
  v_bfe_u32 v1, v0, 4, 1
  v_lshl_add_u32 v6, v1, 3, v6
  v_add_u32 v6, s88, v6
  v_xor_b32 v7, 32, v6
  v_xor_b32 v8, 64, v6
  v_xor_b32 v9, 96, v6
  v_mul_u32_u24 v10, 6, v2
  v_add_lshl_u32 v10, v10, v1, 13
  v_lshl_add_u32 v11, v1, 1, v2
  v_bfe_u32 v1, v0, 3, 1
  v_lshl_add_u32 v11, v11, 1, v1
  v_lshlrev_b32 v11, 10, v11
  v_lshl_add_u32 v11, v5, 4, v11
  v_xor_b32 v5, v5, v1
  v_lshl_add_u32 v10, v5, 4, v10
  s_lshl_b32 s92, s48, 3
  v_add_u32 v1, s92, v1
  v_lshl_add_u32 v10, v1, 7, v10
  v_lshl_add_u32 v1, v2, 1, v1
  v_lshlrev_b32 v1, 2, v1
  v_add_u32 v5, 156224, v1
  s_lshl_b32 s93, s54, 3
  s_add_u32 s93, s93, s48
  s_lshl_b32 s93, s93, 13
  s_lshl_b32 s92, s84, 7
  s_add_u32 s93, s93, s92
  v_and_b32 v1, 1, v0
  v_lshlrev_b32 v1, 4, v1
  v_mov_b32 v2, 0x3f80
  v_lshlrev_b32 v2, v1, v2
  v_bfe_u32 v1, v0, 1, 3
  v_cmp_eq_u32 s[60:61], 0, v1
  v_cmp_eq_u32 s[62:63], 1, v1
  s_nop 0
  v_cndmask_b32 v188, 0, v2, s[60:61]
  v_cmp_eq_u32 s[60:61], 2, v1
  v_cndmask_b32 v189, 0, v2, s[62:63]
  v_cmp_eq_u32 s[62:63], 3, v1
  v_cndmask_b32 v190, 0, v2, s[60:61]
  v_cmp_eq_u32 s[60:61], 4, v1
  v_cndmask_b32 v191, 0, v2, s[62:63]
  v_cmp_eq_u32 s[62:63], 5, v1
  v_cndmask_b32 v12, 0, v2, s[60:61]
  v_cmp_eq_u32 s[60:61], 6, v1
  v_cndmask_b32 v13, 0, v2, s[62:63]
  v_cmp_eq_u32 s[62:63], 7, v1
  v_cndmask_b32 v14, 0, v2, s[60:61]
  s_nop 0
  v_cndmask_b32 v15, 0, v2, s[62:63]
  v_xor_b32 v177, 32, v10
  v_xor_b32 v178, 64, v10
  v_xor_b32 v179, 96, v10
  s_lshl_b32 s56, s48, 10
  s_add_u32 s56, s56, 98304
  v_lshl_add_u32 v176, v0, 4, s56
  s_cmp_lg_u32 s49, 0
  s_cbranch_scc1 L_nopy
  s_mov_b32 s63, 0x80000
SP11:
  s_mov_b32 s62, 0
  s_atomic_add s62, s[6:7], s55 glc
  s_waitcnt lgkmcnt(0)
  s_cmp_ge_u32 s62, 4
  s_cbranch_scc1 SX11
  s_sub_u32 s63, s63, 1
  s_cbranch_scc1 SX11
  s_sleep 5
  s_branch SP11
SX11:
  v_mov_b32 v2, s82
  v_mov_b32 v1, 1
  s_mov_b64 exec, 1
  ds_add_u32 v2, v1 offset:8
  s_mov_b64 exec, -1
L_nopy:
  v_mov_b32 v2, s82
  s_mov_b32 s63, 0x800000
  s_mov_b64 exec, 1
W12:
  ds_read_b32 v1, v2 offset:8
  s_sub_u32 s63, s63, 1
  s_cbranch_scc1 WX12
  s_waitcnt lgkmcnt(0)
  v_cmp_gt_u32 vcc, 2, v1
  s_nop 0
  s_cbranch_vccz WX12
  s_sleep 1
  s_branch W12
WX12:
  s_mov_b64 exec, -1
  s_setprio 2
  s_add_u32 s59, s55, 4096
  s_lshl_b32 s55, s49, 28
  v_lshl_add_u32 v157, v0, 2, s55
  s_lshl_b32 s58, s54, 8
  s_add_u32 s58, s58, 17825792
  s_add_u32 s55, s71, 1520640
  buffer_load_dwordx4 v[128:131], v159, s[20:23], s55 offen sc1
  s_add_u32 s55, s71, 2052864
  buffer_load_dwordx4 v[132:135], v158, s[20:23], s55 offen sc1
  s_add_u32 s55, s71, 2044416
  buffer_load_dwordx4 v[136:139], v158, s[20:23], s55 offen sc1
  s_add_u32 s55, s71, 2035968
  buffer_load_dwordx4 v[140:143], v158, s[20:23], s55 offen sc1
  s_setprio 0
  v_mov_b32 v2, s82
  s_mov_b32 s63, 0x800000
  s_mov_b64 exec, 1
W13:
  ds_read_b32 v1, v2 offset:12
  s_sub_u32 s63, s63, 1
  s_cbranch_scc1 WX13
  s_waitcnt lgkmcnt(0)
  v_cmp_gt_u32 vcc, 4, v1
  s_nop 0
  s_cbranch_vccnz W13
WX13:
  s_mov_b64 exec, -1
  s_waitcnt vmcnt(0)
  s_setprio 2
  s_add_u32 s55, s71, 439296
  buffer_load_dwordx4 v[112:115], v159, s[20:23], s55 offen sc1
  s_add_u32 s55, s71, 971520
  buffer_load_dwordx4 v[116:119], v158, s[20:23], s55 offen sc1
  s_add_u32 s55, s71, 963072
  buffer_load_dwordx4 v[120:123], v158, s[20:23], s55 offen sc1
  s_add_u32 s55, s71, 954624
  buffer_load_dwordx4 v[124:127], v158, s[20:23], s55 offen sc1
  s_setprio 0
  v_swap_b32 v129, v132
  v_swap_b32 v130, v136
  v_swap_b32 v131, v140
  v_swap_b32 v134, v137
  v_swap_b32 v135, v141
  v_swap_b32 v139, v142
  v_mfma_f32_16x16x32_bf16 v[192:195], v[64:67], v[128:131], 0
  v_mfma_f32_16x16x32_bf16 v[208:211], v[68:71], v[128:131], 0
  v_mfma_f32_16x16x32_bf16 v[224:227], v[72:75], v[128:131], 0
  v_mfma_f32_16x16x32_bf16 v[240:243], v[76:79], v[128:131], 0
  v_mfma_f32_16x16x32_bf16 v[196:199], v[64:67], v[132:135], 0
  v_mfma_f32_16x16x32_bf16 v[212:215], v[68:71], v[132:135], 0
  v_mfma_f32_16x16x32_bf16 v[228:231], v[72:75], v[132:135], 0
  v_mfma_f32_16x16x32_bf16 v[244:247], v[76:79], v[132:135], 0
  v_mfma_f32_16x16x32_bf16 v[200:203], v[64:67], v[136:139], 0
  v_mfma_f32_16x16x32_bf16 v[216:219], v[68:71], v[136:139], 0
  v_mfma_f32_16x16x32_bf16 v[232:235], v[72:75], v[136:139], 0
  v_mfma_f32_16x16x32_bf16 v[248:251], v[76:79], v[136:139], 0
  v_mfma_f32_16x16x32_bf16 v[204:207], v[64:67], v[140:143], 0
  v_mfma_f32_16x16x32_bf16 v[220:223], v[68:71], v[140:143], 0
  v_mfma_f32_16x16x32_bf16 v[236:239], v[72:75], v[140:143], 0
  v_mfma_f32_16x16x32_bf16 v[252:255], v[76:79], v[140:143], 0
  s_waitcnt vmcnt(0)
  s_setprio 2
  s_add_u32 s55, s57, 1081344
  buffer_load_dwordx4 v[96:99], v4, s[20:23], s55 offen sc1
  s_add_u32 s55, s57, 1089792
  buffer_load_dwordx4 v[100:103], v4, s[20:23], s55 offen sc1
  s_add_u32 s55, s57, 1098240
  buffer_load_dwordx4 v[104:107], v4, s[20:23], s55 offen sc1
  s_add_u32 s55, s57, 1106688
  buffer_load_dwordx4 v[108:111], v4, s[20:23], s55 offen sc1
  s_setprio 0
  v_swap_b32 v113, v116
  v_swap_b32 v114, v120
  v_swap_b32 v115, v124
  v_swap_b32 v118, v121
  v_swap_b32 v119, v125
  v_swap_b32 v123, v126
  v_mfma_f32_16x16x32_bf16 v[192:195], v[48:51], v[112:115], v[192:195]
  v_mfma_f32_16x16x32_bf16 v[208:211], v[52:55], v[112:115], v[208:211]
  v_mfma_f32_16x16x32_bf16 v[224:227], v[56:59], v[112:115], v[224:227]
  v_mfma_f32_16x16x32_bf16 v[240:243], v[60:63], v[112:115], v[240:243]
  v_mfma_f32_16x16x32_bf16 v[196:199], v[48:51], v[116:119], v[196:199]
  v_mfma_f32_16x16x32_bf16 v[212:215], v[52:55], v[116:119], v[212:215]
  v_mfma_f32_16x16x32_bf16 v[228:231], v[56:59], v[116:119], v[228:231]
  v_mfma_f32_16x16x32_bf16 v[244:247], v[60:63], v[116:119], v[244:247]
  v_mfma_f32_16x16x32_bf16 v[200:203], v[48:51], v[120:123], v[200:203]
  v_mfma_f32_16x16x32_bf16 v[216:219], v[52:55], v[120:123], v[216:219]
  v_mfma_f32_16x16x32_bf16 v[232:235], v[56:59], v[120:123], v[232:235]
  v_mfma_f32_16x16x32_bf16 v[248:251], v[60:63], v[120:123], v[248:251]
  v_mfma_f32_16x16x32_bf16 v[204:207], v[48:51], v[124:127], v[204:207]
  v_mfma_f32_16x16x32_bf16 v[220:223], v[52:55], v[124:127], v[220:223]
  v_mfma_f32_16x16x32_bf16 v[236:239], v[56:59], v[124:127], v[236:239]
  v_mfma_f32_16x16x32_bf16 v[252:255], v[60:63], v[124:127], v[252:255]
  s_cmp_lg_u32 s49, 0
  s_cbranch_scc1 L_noa0
  s_mov_b32 s95, 0
  s_atomic_add s95, s[6:7], s59 glc
L_noa0:
  s_waitcnt vmcnt(0)
  s_setprio 2
  s_cmp_lg_u32 s49, 0
  s_cbranch_scc1 L_nop0
  s_waitcnt lgkmcnt(0)
  s_cmp_ge_u32 s95, 1
  s_cbranch_scc1 SX14
  s_mov_b32 s63, 0x80000
SP14:
  s_mov_b32 s62, 0
  s_atomic_add s62, s[6:7], s59 glc
  s_waitcnt lgkmcnt(0)
  s_cmp_ge_u32 s62, 1
  s_cbranch_scc1 SX14
  s_sub_u32 s63, s63, 1
  s_cbranch_scc1 SX14
  s_sleep 5
  s_branch SP14
SX14:
L_nop0:
  buffer_load_dword v180, v157, s[20:23], s58 offen sc1
  s_add_u32 s55, s57, 0
  buffer_load_dwordx4 v[80:83], v4, s[20:23], s55 offen sc1
  s_add_u32 s55, s57, 8448
  buffer_load_dwordx4 v[84:87], v4, s[20:23], s55 offen sc1
  s_add_u32 s55, s57, 16896
  buffer_load_dwordx4 v[88:91], v4, s[20:23], s55 offen sc1
  s_add_u32 s55, s57, 25344
  buffer_load_dwordx4 v[92:95], v4, s[20:23], s55 offen sc1
  s_setprio 0
  v_swap_b32 v97, v100
  v_swap_b32 v98, v104
  v_swap_b32 v99, v108
  v_swap_b32 v102, v105
  v_swap_b32 v103, v109
  v_swap_b32 v107, v110
  v_mfma_f32_16x16x32_bf16 v[192:195], v[32:35], v[96:99], v[192:195]
  v_mfma_f32_16x16x32_bf16 v[208:211], v[36:39], v[96:99], v[208:211]
  v_mfma_f32_16x16x32_bf16 v[224:227], v[40:43], v[96:99], v[224:227]
  v_mfma_f32_16x16x32_bf16 v[240:243], v[44:47], v[96:99], v[240:243]
  v_mfma_f32_16x16x32_bf16 v[196:199], v[32:35], v[100:103], v[196:199]
  v_mfma_f32_16x16x32_bf16 v[212:215], v[36:39], v[100:103], v[212:215]
  v_mfma_f32_16x16x32_bf16 v[228:231], v[40:43], v[100:103], v[228:231]
  v_mfma_f32_16x16x32_bf16 v[244:247], v[44:47], v[100:103], v[244:247]
  v_mfma_f32_16x16x32_bf16 v[200:203], v[32:35], v[104:107], v[200:203]
  v_mfma_f32_16x16x32_bf16 v[216:219], v[36:39], v[104:107], v[216:219]
  v_mfma_f32_16x16x32_bf16 v[232:235], v[40:43], v[104:107], v[232:235]
  v_mfma_f32_16x16x32_bf16 v[248:251], v[44:47], v[104:107], v[248:251]
  v_mfma_f32_16x16x32_bf16 v[204:207], v[32:35], v[108:111], v[204:207]
  v_mfma_f32_16x16x32_bf16 v[220:223], v[36:39], v[108:111], v[220:223]
  v_mfma_f32_16x16x32_bf16 v[236:239], v[40:43], v[108:111], v[236:239]
  v_mfma_f32_16x16x32_bf16 v[252:255], v[44:47], v[108:111], v[252:255]
  s_waitcnt vmcnt(0)
  v_swap_b32 v81, v84
  v_swap_b32 v82, v88
  v_swap_b32 v83, v92
  v_swap_b32 v86, v89
  v_swap_b32 v87, v93
  v_swap_b32 v91, v94
  v_mfma_f32_16x16x32_bf16 v[192:195], v[16:19], v[80:83], v[192:195]
  v_mfma_f32_16x16x32_bf16 v[208:211], v[20:23], v[80:83], v[208:211]
  v_mfma_f32_16x16x32_bf16 v[224:227], v[24:27], v[80:83], v[224:227]
  v_mfma_f32_16x16x32_bf16 v[240:243], v[28:31], v[80:83], v[240:243]
  v_mfma_f32_16x16x32_bf16 v[196:199], v[16:19], v[84:87], v[196:199]
  v_mfma_f32_16x16x32_bf16 v[212:215], v[20:23], v[84:87], v[212:215]
  s_nop 2
  v_cvt_pk_bf16_f32 v192, v192, v193
  v_cvt_pk_bf16_f32 v193, v194, v195
  ds_write_b64 v6, v[192:193] offset:0
  v_cvt_pk_bf16_f32 v208, v208, v209
  v_mfma_f32_16x16x32_bf16 v[228:231], v[24:27], v[84:87], v[228:231]
  v_cvt_pk_bf16_f32 v209, v210, v211
  ds_write_b64 v7, v[208:209] offset:0
  v_cvt_pk_bf16_f32 v224, v224, v225
  v_cvt_pk_bf16_f32 v225, v226, v227
  v_mfma_f32_16x16x32_bf16 v[244:247], v[28:31], v[84:87], v[244:247]
  ds_write_b64 v8, v[224:225] offset:0
  v_cvt_pk_bf16_f32 v240, v240, v241
  v_cvt_pk_bf16_f32 v241, v242, v243
  ds_write_b64 v9, v[240:241] offset:0
  v_mfma_f32_16x16x32_bf16 v[200:203], v[16:19], v[88:91], v[200:203]
  v_mfma_f32_16x16x32_bf16 v[216:219], v[20:23], v[88:91], v[216:219]
  v_cvt_pk_bf16_f32 v196, v196, v197
  v_cvt_pk_bf16_f32 v197, v198, v199
  ds_write_b64 v6, v[196:197] offset:2048
  v_cvt_pk_bf16_f32 v212, v212, v213
  v_mfma_f32_16x16x32_bf16 v[232:235], v[24:27], v[88:91], v[232:235]
  v_cvt_pk_bf16_f32 v213, v214, v215
  ds_write_b64 v7, v[212:213] offset:2048
  v_cvt_pk_bf16_f32 v228, v228, v229
  v_cvt_pk_bf16_f32 v229, v230, v231
  v_mfma_f32_16x16x32_bf16 v[248:251], v[28:31], v[88:91], v[248:251]
  ds_write_b64 v8, v[228:229] offset:2048
  v_cvt_pk_bf16_f32 v244, v244, v245
  v_cvt_pk_bf16_f32 v245, v246, v247
  ds_write_b64 v9, v[244:245] offset:2048
  v_mfma_f32_16x16x32_bf16 v[204:207], v[16:19], v[92:95], v[204:207]
  v_mfma_f32_16x16x32_bf16 v[220:223], v[20:23], v[92:95], v[220:223]
  v_cvt_pk_bf16_f32 v200, v200, v201
  v_cvt_pk_bf16_f32 v201, v202, v203
  ds_write_b64 v6, v[200:201] offset:4096
  v_cvt_pk_bf16_f32 v216, v216, v217
  v_mfma_f32_16x16x32_bf16 v[236:239], v[24:27], v[92:95], v[236:239]
  v_cvt_pk_bf16_f32 v217, v218, v219
  ds_write_b64 v7, v[216:217] offset:4096
  v_cvt_pk_bf16_f32 v232, v232, v233
  v_cvt_pk_bf16_f32 v233, v234, v235
  v_mfma_f32_16x16x32_bf16 v[252:255], v[28:31], v[92:95], v[252:255]
  ds_write_b64 v8, v[232:233] offset:4096
  v_cvt_pk_bf16_f32 v248, v248, v249
  v_cvt_pk_bf16_f32 v249, v250, v251
  ds_write_b64 v9, v[248:249] offset:4096
  s_cmp_lg_u32 s49, 0
  s_cbranch_scc1 L_part
  v_add_u32 v157, 156224, v157
  ds_write_b32 v157, v180
L_part:
  s_setprio 0
  v_cvt_pk_bf16_f32 v204, v204, v205
  v_cvt_pk_bf16_f32 v205, v206, v207
  ds_write_b64 v6, v[204:205] offset:6144
  v_cvt_pk_bf16_f32 v220, v220, v221
  v_cvt_pk_bf16_f32 v221, v222, v223
  ds_write_b64 v7, v[220:221] offset:6144
  v_cvt_pk_bf16_f32 v236, v236, v237
  v_cvt_pk_bf16_f32 v237, v238, v239
  ds_write_b64 v8, v[236:237] offset:6144
  v_cvt_pk_bf16_f32 v252, v252, v253
  v_cvt_pk_bf16_f32 v253, v254, v255
  ds_write_b64 v9, v[252:253] offset:6144
  s_waitcnt vmcnt(0) lgkmcnt(0)
  s_barrier
  ds_read_b128 v[16:19], v176
  ds_read_b128 v[32:35], v10 offset:0
  ds_read_b128 v[36:39], v177 offset:256
  ds_read_b128 v[40:43], v178 offset:512
  ds_read_b128 v[44:47], v179 offset:768
  ds_read2_b32 v[24:25], v5 offset1:4
  ds_read_b128 v[48:51], v10 offset:16384
  ds_read_b128 v[52:55], v177 offset:16640
  ds_read_b128 v[56:59], v178 offset:16896
  ds_read_b128 v[60:63], v179 offset:17152
  s_waitcnt lgkmcnt(9)
  v_lshlrev_b32 v72, 16, v16
  v_and_b32 v73, 0xffff0000, v16
  v_lshlrev_b32 v74, 16, v17
  v_and_b32 v75, 0xffff0000, v17
  v_lshlrev_b32 v76, 16, v18
  v_and_b32 v77, 0xffff0000, v18
  v_lshlrev_b32 v78, 16, v19
  v_and_b32 v79, 0xffff0000, v19
  s_waitcnt lgkmcnt(8)
  v_mfma_f32_16x16x32_bf16 v[64:67], v[188:191], v[32:35], 0
  s_waitcnt lgkmcnt(6)
  v_mfma_f32_16x16x32_bf16 v[68:71], v[188:191], v[40:43], 0
  v_mfma_f32_16x16x32_bf16 v[64:67], v[12:15], v[36:39], v[64:67]
  s_waitcnt lgkmcnt(5)
  v_mfma_f32_16x16x32_bf16 v[68:71], v[12:15], v[44:47], v[68:71]
  s_waitcnt lgkmcnt(4)
  v_sub_f32 v28, 1.0, v24
  v_mul_f32 v29, 0x36000000, v24
  v_sub_f32 v30, 1.0, v25
  v_mul_f32 v31, 0x36000000, v25
  v_cvt_pk_bf16_f32 v28, 0, v28
  v_cvt_pk_bf16_f32 v30, 0, v30
  s_waitcnt lgkmcnt(3)
  v_mfma_f32_16x16x32_bf16 v[72:75], v[188:191], v[48:51], v[72:75]
  s_waitcnt lgkmcnt(1)
  v_mfma_f32_16x16x32_bf16 v[76:79], v[188:191], v[56:59], v[76:79]
  v_mfma_f32_16x16x32_bf16 v[72:75], v[12:15], v[52:55], v[72:75]
  s_waitcnt lgkmcnt(0)
  v_mfma_f32_16x16x32_bf16 v[76:79], v[12:15], v[60:63], v[76:79]
  v_mul_f32 v64, v64, v29
  v_mul_f32 v65, v65, v29
  v_mul_f32 v66, v66, v29
  v_mul_f32 v67, v67, v29
  v_mul_f32 v68, v68, v31
  v_mul_f32 v69, v69, v31
  v_mul_f32 v70, v70, v31
  v_mul_f32 v71, v71, v31
  s_nop 0
  v_fmac_f32 v64, v72, v28
  v_fmac_f32 v65, v73, v28
  v_fmac_f32 v66, v74, v28
  v_fmac_f32 v67, v75, v28
  v_cvt_pk_bf16_f32 v32, v64, v65
  v_cvt_pk_bf16_f32 v33, v66, v67
  v_fmac_f32 v68, v76, v30
  v_fmac_f32 v69, v77, v30
  v_fmac_f32 v70, v78, v30
  v_fmac_f32 v71, v79, v30
  v_cvt_pk_bf16_f32 v34, v68, v69
  v_cvt_pk_bf16_f32 v35, v70, v71
  s_nop 0
  v_permlane16_swap_b32 v32, v34
  v_permlane16_swap_b32 v33, v35
  buffer_store_dwordx4 v[32:35], v11, s[28:31], s93 offen sc1
  s_endpgm
L_comp:
  s_load_dwordx2 s[24:25], s[0:1], 48
  s_mov_b32 s26, 1835008
  s_mov_b32 s27, 0x20000
  s_load_dwordx2 s[28:29], s[0:1], 64
  s_mov_b32 s30, 2097152
  s_mov_b32 s31, 0x20000
  s_load_dwordx2 s[32:33], s[0:1], 72
  s_mov_b32 s34, 256
  s_mov_b32 s35, 0x20000
  s_load_dwordx2 s[36:37], s[0:1], 8
  s_mov_b32 s38, 1052672
  s_mov_b32 s39, 0x20000
  s_load_dwordx2 s[40:41], s[0:1], 16
  s_mov_b32 s42, 1052672
  s_mov_b32 s43, 0x20000
  v_and_b32 v1, 15, v0
  v_lshlrev_b32 v1, 2, v1
  v_add_u32 v1, 156160, v1
  v_mov_b32 v2, 0
  ds_write_b32 v1, v2
  v_lshrrev_b32 v1, 3, v0
  v_lshlrev_b32 v1, 10, v1
  v_lshrrev_b32 v2, 4, v0
  v_lshlrev_b32 v2, 1, v2
  v_and_b32 v116, 7, v0
  v_xor_b32 v2, v2, v116
  v_lshl_add_u32 v1, v2, 4, v1
  s_lshl_b32 s55, s84, 7
  s_lshl_b32 s56, s49, 15
  s_add_u32 s55, s55, s56
  s_mul_i32 s56, s52, 917504
  s_add_u32 s55, s55, s56
  v_add_u32 v116, s55, v1
  v_add_u32 v117, 7168, v116
  v_add_u32 v118, 14336, v116
  v_add_u32 v119, 21504, v116
  s_and_b32 s85, s50, 0
  s_mul_i32 s85, s85, 0
  s_add_u32 s85, s85, s51
  s_sub_u32 s55, s85, 7
  s_cselect_b32 s85, s85, s55
  s_sub_u32 s55, s85, 7
  s_cselect_b32 s85, s85, s55
  s_mul_i32 s87, s49, 12288
  s_add_u32 s87, s87, 98304
  s_lshr_b32 s88, s49, 1
  s_mul_i32 s88, s88, 4
  s_add_u32 s88, s88, s49
  s_add_u32 s88, s88, 2
  s_lshl_b32 s88, s88, 13
  s_mul_i32 s55, s52, 7
  s_add_u32 s55, s55, s51
  s_lshl_b32 s55, s55, 2
  s_add_u32 s55, s55, s49
  s_lshl_b32 s55, s55, 12
  s_mul_i32 s56, s54, 229632
  s_add_u32 s65, s55, s56
  s_xor_b32 s56, s54, 1
  s_mul_i32 s56, s56, 229632
  s_add_u32 s64, s55, s56
  v_lshlrev_b32 v112, 4, v0
  v_mov_b32 v113, 156160
  v_mov_b32 v114, 1
  v_and_b32 v1, 15, v0
  v_lshrrev_b32 v2, 4, v0
  v_bfe_u32 v8, v0, 1, 3
  v_xor_b32 v8, v8, v2
  v_lshlrev_b32 v8, 4, v8
  v_lshl_add_u32 v8, v1, 7, v8
  v_xor_b32 v9, 64, v8
  v_bfe_u32 v1, v0, 2, 2
  v_lshl_add_u32 v10, v2, 3, v1
  v_lshlrev_b32 v10, 8, v10
  v_xor_b32 v1, s49, v1
  v_lshl_add_u32 v10, v1, 6, v10
  v_and_b32 v2, 1, v2
  v_lshl_add_u32 v10, v2, 5, v10
  v_and_b32 v1, 3, v0
  v_lshl_add_u32 v10, v1, 3, v10
  v_add_u32 v10, 16384, v10
  v_xor_b32 v11, 32, v10
  v_mov_b32 v4, v8
  v_mov_b32 v5, v9
  v_mov_b32 v6, v10
  v_mov_b32 v7, v11
  s_waitcnt vmcnt(0)
  v_mov_b32 v128, 0
  v_mov_b32 v129, 0
  v_mov_b32 v130, 0
  v_mov_b32 v131, 0
  v_mov_b32 v132, 0
  v_mov_b32 v133, 0
  v_mov_b32 v134, 0
  v_mov_b32 v135, 0
  v_mov_b32 v136, 0
  v_mov_b32 v137, 0
  v_mov_b32 v138, 0
  v_mov_b32 v139, 0
  v_mov_b32 v140, 0
  v_mov_b32 v141, 0
  v_mov_b32 v142, 0
  v_mov_b32 v143, 0
  v_mov_b32 v144, 0
  v_mov_b32 v145, 0
  v_mov_b32 v146, 0
  v_mov_b32 v147, 0
  v_mov_b32 v148, 0
  v_mov_b32 v149, 0
  v_mov_b32 v150, 0
  v_mov_b32 v151, 0
  v_mov_b32 v152, 0
  v_mov_b32 v153, 0
  v_mov_b32 v154, 0
  v_mov_b32 v155, 0
  v_mov_b32 v156, 0
  v_mov_b32 v157, 0
  v_mov_b32 v158, 0
  v_mov_b32 v159, 0
  v_mov_b32 v160, 0
  v_mov_b32 v161, 0
  v_mov_b32 v162, 0
  v_mov_b32 v163, 0
  v_mov_b32 v164, 0
  v_mov_b32 v165, 0
  v_mov_b32 v166, 0
  v_mov_b32 v167, 0
  v_mov_b32 v168, 0
  v_mov_b32 v169, 0
  v_mov_b32 v170, 0
  v_mov_b32 v171, 0
  v_mov_b32 v172, 0
  v_mov_b32 v173, 0
  v_mov_b32 v174, 0
  v_mov_b32 v175, 0
  v_mov_b32 v176, 0
  v_mov_b32 v177, 0
  v_mov_b32 v178, 0
  v_mov_b32 v179, 0
  v_mov_b32 v180, 0
  v_mov_b32 v181, 0
  v_mov_b32 v182, 0
  v_mov_b32 v183, 0
  v_mov_b32 v184, 0
  v_mov_b32 v185, 0
  v_mov_b32 v186, 0
  v_mov_b32 v187, 0
  v_mov_b32 v188, 0
  v_mov_b32 v189, 0
  v_mov_b32 v190, 0
  v_mov_b32 v191, 0
  v_mov_b32 v192, 0
  v_mov_b32 v193, 0
  v_mov_b32 v194, 0
  v_mov_b32 v195, 0
  v_mov_b32 v196, 0
  v_mov_b32 v197, 0
  v_mov_b32 v198, 0
  v_mov_b32 v199, 0
  v_mov_b32 v200, 0
  v_mov_b32 v201, 0
  v_mov_b32 v202, 0
  v_mov_b32 v203, 0
  v_mov_b32 v204, 0
  v_mov_b32 v205, 0
  v_mov_b32 v206, 0
  v_mov_b32 v207, 0
  v_mov_b32 v208, 0
  v_mov_b32 v209, 0
  v_mov_b32 v210, 0
  v_mov_b32 v211, 0
  v_mov_b32 v212, 0
  v_mov_b32 v213, 0
  v_mov_b32 v214, 0
  v_mov_b32 v215, 0
  v_mov_b32 v216, 0
  v_mov_b32 v217, 0
  v_mov_b32 v218, 0
  v_mov_b32 v219, 0
  v_mov_b32 v220, 0
  v_mov_b32 v221, 0
  v_mov_b32 v222, 0
  v_mov_b32 v223, 0
  v_mov_b32 v224, 0
  v_mov_b32 v225, 0
  v_mov_b32 v226, 0
  v_mov_b32 v227, 0
  v_mov_b32 v228, 0
  v_mov_b32 v229, 0
  v_mov_b32 v230, 0
  v_mov_b32 v231, 0
  v_mov_b32 v232, 0
  v_mov_b32 v233, 0
  v_mov_b32 v234, 0
  v_mov_b32 v235, 0
  v_mov_b32 v236, 0
  v_mov_b32 v237, 0
  v_mov_b32 v238, 0
  v_mov_b32 v239, 0
  v_mov_b32 v240, 0
  v_mov_b32 v241, 0
  v_mov_b32 v242, 0
  v_mov_b32 v243, 0
  v_mov_b32 v244, 0
  v_mov_b32 v245, 0
  v_mov_b32 v246, 0
  v_mov_b32 v247, 0
  v_mov_b32 v248, 0
  v_mov_b32 v249, 0
  v_mov_b32 v250, 0
  v_mov_b32 v251, 0
  v_mov_b32 v252, 0
  v_mov_b32 v253, 0
  v_mov_b32 v254, 0
  v_mov_b32 v255, 0
  s_mov_b32 s57, 0
  s_mov_b32 s58, 6
  s_waitcnt lgkmcnt(0)
  s_add_u32 s6, s20, 17891328
  s_addc_u32 s7, s21, 0
  s_mov_b32 s81, 1
  s_mov_b32 s82, 156160
  s_mov_b32 s83, 147456
  s_barrier
  ds_read_b64_tr_b16 v[48:49], v6 offset:0
  ds_read_b64_tr_b16 v[50:51], v6 offset:1024
  ds_read_b128 v[16:19], v4 offset:0
  ds_read_b64_tr_b16 v[52:53], v7 offset:0
  ds_read_b64_tr_b16 v[54:55], v7 offset:1024
  ds_read_b64_tr_b16 v[56:57], v6 offset:16384
  ds_read_b64_tr_b16 v[58:59], v6 offset:17408
  ds_read_b64_tr_b16 v[60:61], v7 offset:16384
  ds_read_b64_tr_b16 v[62:63], v7 offset:17408
  s_waitcnt lgkmcnt(6)
  v_mfma_f32_16x16x32_bf16 v[128:131], v[48:51], v[16:19], v[128:131]
  s_waitcnt lgkmcnt(4)
  v_mfma_f32_16x16x32_bf16 v[132:135], v[52:55], v[16:19], v[132:135]
  s_waitcnt lgkmcnt(2)
  v_mfma_f32_16x16x32_bf16 v[136:139], v[56:59], v[16:19], v[136:139]
  s_waitcnt lgkmcnt(0)
  v_mfma_f32_16x16x32_bf16 v[140:143], v[60:63], v[16:19], v[140:143]
  ds_read_b128 v[20:23], v4 offset:2048
  s_waitcnt lgkmcnt(0)
  v_mfma_f32_16x16x32_bf16 v[156:159], v[60:63], v[20:23], v[156:159]
  v_mfma_f32_16x16x32_bf16 v[152:155], v[56:59], v[20:23], v[152:155]
  v_mfma_f32_16x16x32_bf16 v[148:151], v[52:55], v[20:23], v[148:151]
  v_mfma_f32_16x16x32_bf16 v[144:147], v[48:51], v[20:23], v[144:147]
  ds_read_b128 v[24:27], v4 offset:4096
  s_waitcnt lgkmcnt(0)
  v_mfma_f32_16x16x32_bf16 v[160:163], v[48:51], v[24:27], v[160:163]
  v_mfma_f32_16x16x32_bf16 v[164:167], v[52:55], v[24:27], v[164:167]
  v_mfma_f32_16x16x32_bf16 v[168:171], v[56:59], v[24:27], v[168:171]
  v_mfma_f32_16x16x32_bf16 v[172:175], v[60:63], v[24:27], v[172:175]
  ds_read_b128 v[28:31], v4 offset:6144
  s_waitcnt lgkmcnt(0)
  v_mfma_f32_16x16x32_bf16 v[188:191], v[60:63], v[28:31], v[188:191]
  v_mfma_f32_16x16x32_bf16 v[184:187], v[56:59], v[28:31], v[184:187]
  v_mfma_f32_16x16x32_bf16 v[180:183], v[52:55], v[28:31], v[180:183]
  v_mfma_f32_16x16x32_bf16 v[176:179], v[48:51], v[28:31], v[176:179]
  ds_read_b128 v[32:35], v4 offset:8192
  s_waitcnt lgkmcnt(0)
  v_mfma_f32_16x16x32_bf16 v[192:195], v[48:51], v[32:35], v[192:195]
  v_mfma_f32_16x16x32_bf16 v[196:199], v[52:55], v[32:35], v[196:199]
  v_mfma_f32_16x16x32_bf16 v[200:203], v[56:59], v[32:35], v[200:203]
  v_mfma_f32_16x16x32_bf16 v[204:207], v[60:63], v[32:35], v[204:207]
  ds_read_b128 v[36:39], v4 offset:10240
  s_waitcnt lgkmcnt(0)
  v_mfma_f32_16x16x32_bf16 v[220:223], v[60:63], v[36:39], v[220:223]
  v_mfma_f32_16x16x32_bf16 v[216:219], v[56:59], v[36:39], v[216:219]
  v_mfma_f32_16x16x32_bf16 v[212:215], v[52:55], v[36:39], v[212:215]
  v_mfma_f32_16x16x32_bf16 v[208:211], v[48:51], v[36:39], v[208:211]
  ds_read_b128 v[40:43], v4 offset:12288
  s_waitcnt lgkmcnt(0)
  v_mfma_f32_16x16x32_bf16 v[224:227], v[48:51], v[40:43], v[224:227]
  v_mfma_f32_16x16x32_bf16 v[228:231], v[52:55], v[40:43], v[228:231]
  v_mfma_f32_16x16x32_bf16 v[232:235], v[56:59], v[40:43], v[232:235]
  v_mfma_f32_16x16x32_bf16 v[236:239], v[60:63], v[40:43], v[236:239]
  ds_read_b128 v[44:47], v4 offset:14336
  s_waitcnt lgkmcnt(0)
  v_mfma_f32_16x16x32_bf16 v[252:255], v[60:63], v[44:47], v[252:255]
  s_barrier
  ds_read_b64_tr_b16 v[64:65], v6 offset:8192
  ds_read_b64_tr_b16 v[66:67], v6 offset:9216
  v_mfma_f32_16x16x32_bf16 v[248:251], v[56:59], v[44:47], v[248:251]
  ds_read_b64_tr_b16 v[68:69], v7 offset:8192
  ds_read_b64_tr_b16 v[70:71], v7 offset:9216
  v_mfma_f32_16x16x32_bf16 v[244:247], v[52:55], v[44:47], v[244:247]
  ds_read_b64_tr_b16 v[72:73], v6 offset:24576
  ds_read_b64_tr_b16 v[74:75], v6 offset:25600
  v_mfma_f32_16x16x32_bf16 v[240:243], v[48:51], v[44:47], v[240:243]
  ds_read_b128 v[16:19], v5 offset:0
  ds_read_b64_tr_b16 v[76:77], v7 offset:24576
  ds_read_b64_tr_b16 v[78:79], v7 offset:25600
  s_waitcnt lgkmcnt(2)
  v_mfma_f32_16x16x32_bf16 v[128:131], v[64:67], v[16:19], v[128:131]
  v_mfma_f32_16x16x32_bf16 v[132:135], v[68:71], v[16:19], v[132:135]
  v_mfma_f32_16x16x32_bf16 v[136:139], v[72:75], v[16:19], v[136:139]
  s_waitcnt lgkmcnt(0)
  v_mfma_f32_16x16x32_bf16 v[140:143], v[76:79], v[16:19], v[140:143]
  ds_read_b128 v[20:23], v5 offset:2048
  s_waitcnt lgkmcnt(0)
  v_mfma_f32_16x16x32_bf16 v[156:159], v[76:79], v[20:23], v[156:159]
  v_mfma_f32_16x16x32_bf16 v[152:155], v[72:75], v[20:23], v[152:155]
  v_mfma_f32_16x16x32_bf16 v[148:151], v[68:71], v[20:23], v[148:151]
  v_mfma_f32_16x16x32_bf16 v[144:147], v[64:67], v[20:23], v[144:147]
  ds_read_b128 v[24:27], v5 offset:4096
  s_waitcnt lgkmcnt(0)
  v_mfma_f32_16x16x32_bf16 v[160:163], v[64:67], v[24:27], v[160:163]
  v_mfma_f32_16x16x32_bf16 v[164:167], v[68:71], v[24:27], v[164:167]
  v_mfma_f32_16x16x32_bf16 v[168:171], v[72:75], v[24:27], v[168:171]
  v_mfma_f32_16x16x32_bf16 v[172:175], v[76:79], v[24:27], v[172:175]
  ds_read_b128 v[28:31], v5 offset:6144
  s_waitcnt lgkmcnt(0)
  v_mfma_f32_16x16x32_bf16 v[188:191], v[76:79], v[28:31], v[188:191]
  v_mfma_f32_16x16x32_bf16 v[184:187], v[72:75], v[28:31], v[184:187]
  v_mfma_f32_16x16x32_bf16 v[180:183], v[68:71], v[28:31], v[180:183]
  v_mfma_f32_16x16x32_bf16 v[176:179], v[64:67], v[28:31], v[176:179]
  ds_read_b128 v[32:35], v5 offset:8192
  s_waitcnt lgkmcnt(0)
  v_mfma_f32_16x16x32_bf16 v[192:195], v[64:67], v[32:35], v[192:195]
  v_mfma_f32_16x16x32_bf16 v[196:199], v[68:71], v[32:35], v[196:199]
  v_mfma_f32_16x16x32_bf16 v[200:203], v[72:75], v[32:35], v[200:203]
  v_mfma_f32_16x16x32_bf16 v[204:207], v[76:79], v[32:35], v[204:207]
  ds_read_b128 v[36:39], v5 offset:10240
  s_waitcnt lgkmcnt(0)
  v_mfma_f32_16x16x32_bf16 v[220:223], v[76:79], v[36:39], v[220:223]
  v_mfma_f32_16x16x32_bf16 v[216:219], v[72:75], v[36:39], v[216:219]
  v_mfma_f32_16x16x32_bf16 v[212:215], v[68:71], v[36:39], v[212:215]
  v_mfma_f32_16x16x32_bf16 v[208:211], v[64:67], v[36:39], v[208:211]
  ds_read_b128 v[40:43], v5 offset:12288
  s_waitcnt lgkmcnt(0)
  v_mfma_f32_16x16x32_bf16 v[224:227], v[64:67], v[40:43], v[224:227]
  v_mfma_f32_16x16x32_bf16 v[228:231], v[68:71], v[40:43], v[228:231]
  v_mfma_f32_16x16x32_bf16 v[232:235], v[72:75], v[40:43], v[232:235]
  v_mfma_f32_16x16x32_bf16 v[236:239], v[76:79], v[40:43], v[236:239]
  ds_read_b128 v[44:47], v5 offset:14336
  s_waitcnt lgkmcnt(0)
  s_waitcnt lgkmcnt(0)
  v_mfma_f32_16x16x32_bf16 v[252:255], v[76:79], v[44:47], v[252:255]
  s_add_u32 s57, s57, 49152
  s_cmp_eq_u32 s57, 147456
  s_cselect_b32 s57, 0, s57
  s_barrier
  v_add_u32 v6, s57, v10
  v_add_u32 v4, s57, v8
  v_add_u32 v7, s57, v11
  v_add_u32 v5, s57, v9
  v_mfma_f32_16x16x32_bf16 v[248:251], v[72:75], v[44:47], v[248:251]
  ds_read_b64_tr_b16 v[48:49], v6 offset:0
  ds_read_b64_tr_b16 v[50:51], v6 offset:1024
  ds_read_b128 v[16:19], v4 offset:0
  v_mfma_f32_16x16x32_bf16 v[244:247], v[68:71], v[44:47], v[244:247]
  ds_read_b64_tr_b16 v[52:53], v7 offset:0
  ds_read_b64_tr_b16 v[54:55], v7 offset:1024
  ds_read_b64_tr_b16 v[56:57], v6 offset:16384
  v_mfma_f32_16x16x32_bf16 v[240:243], v[64:67], v[44:47], v[240:243]
  ds_read_b64_tr_b16 v[58:59], v6 offset:17408
  ds_read_b64_tr_b16 v[60:61], v7 offset:16384
  ds_read_b64_tr_b16 v[62:63], v7 offset:17408
  s_waitcnt lgkmcnt(6)
  v_mfma_f32_16x16x32_bf16 v[128:131], v[48:51], v[16:19], v[128:131]
  s_waitcnt lgkmcnt(4)
  v_mfma_f32_16x16x32_bf16 v[132:135], v[52:55], v[16:19], v[132:135]
  s_waitcnt lgkmcnt(2)
  v_mfma_f32_16x16x32_bf16 v[136:139], v[56:59], v[16:19], v[136:139]
  s_waitcnt lgkmcnt(0)
  v_mfma_f32_16x16x32_bf16 v[140:143], v[60:63], v[16:19], v[140:143]
  ds_read_b128 v[20:23], v4 offset:2048
  s_waitcnt lgkmcnt(0)
  v_mfma_f32_16x16x32_bf16 v[156:159], v[60:63], v[20:23], v[156:159]
  v_mfma_f32_16x16x32_bf16 v[152:155], v[56:59], v[20:23], v[152:155]
  ds_read_b64_tr_b16 v[64:65], v6 offset:8192
  v_mfma_f32_16x16x32_bf16 v[148:151], v[52:55], v[20:23], v[148:151]
  v_mfma_f32_16x16x32_bf16 v[144:147], v[48:51], v[20:23], v[144:147]
  ds_read_b128 v[24:27], v4 offset:4096
  ds_read_b64_tr_b16 v[66:67], v6 offset:9216
  s_waitcnt lgkmcnt(1)
  v_mfma_f32_16x16x32_bf16 v[160:163], v[48:51], v[24:27], v[160:163]
  v_mfma_f32_16x16x32_bf16 v[164:167], v[52:55], v[24:27], v[164:167]
  ds_read_b64_tr_b16 v[68:69], v7 offset:8192
  v_mfma_f32_16x16x32_bf16 v[168:171], v[56:59], v[24:27], v[168:171]
  v_mfma_f32_16x16x32_bf16 v[172:175], v[60:63], v[24:27], v[172:175]
  ds_read_b128 v[28:31], v4 offset:6144
  ds_read_b64_tr_b16 v[70:71], v7 offset:9216
  s_waitcnt lgkmcnt(1)
  v_mfma_f32_16x16x32_bf16 v[188:191], v[60:63], v[28:31], v[188:191]
  v_mfma_f32_16x16x32_bf16 v[184:187], v[56:59], v[28:31], v[184:187]
  ds_read_b64_tr_b16 v[72:73], v6 offset:24576
  v_mfma_f32_16x16x32_bf16 v[180:183], v[52:55], v[28:31], v[180:183]
  v_mfma_f32_16x16x32_bf16 v[176:179], v[48:51], v[28:31], v[176:179]
  ds_read_b128 v[32:35], v4 offset:8192
  ds_read_b64_tr_b16 v[74:75], v6 offset:25600
  s_waitcnt lgkmcnt(1)
  v_mfma_f32_16x16x32_bf16 v[192:195], v[48:51], v[32:35], v[192:195]
  v_mfma_f32_16x16x32_bf16 v[196:199], v[52:55], v[32:35], v[196:199]
  ds_read_b64_tr_b16 v[76:77], v7 offset:24576
  v_mfma_f32_16x16x32_bf16 v[200:203], v[56:59], v[32:35], v[200:203]
  v_mfma_f32_16x16x32_bf16 v[204:207], v[60:63], v[32:35], v[204:207]
  ds_read_b128 v[36:39], v4 offset:10240
  ds_read_b64_tr_b16 v[78:79], v7 offset:25600
  s_waitcnt lgkmcnt(1)
  v_mfma_f32_16x16x32_bf16 v[220:223], v[60:63], v[36:39], v[220:223]
  v_mfma_f32_16x16x32_bf16 v[216:219], v[56:59], v[36:39], v[216:219]
  v_mfma_f32_16x16x32_bf16 v[212:215], v[52:55], v[36:39], v[212:215]
  v_mfma_f32_16x16x32_bf16 v[208:211], v[48:51], v[36:39], v[208:211]
  ds_read_b128 v[40:43], v4 offset:12288
  s_waitcnt lgkmcnt(0)
  v_mfma_f32_16x16x32_bf16 v[224:227], v[48:51], v[40:43], v[224:227]
  v_mfma_f32_16x16x32_bf16 v[228:231], v[52:55], v[40:43], v[228:231]
  v_mfma_f32_16x16x32_bf16 v[232:235], v[56:59], v[40:43], v[232:235]
  v_mfma_f32_16x16x32_bf16 v[236:239], v[60:63], v[40:43], v[236:239]
  ds_read_b128 v[44:47], v4 offset:14336
  s_waitcnt lgkmcnt(0)
  v_mfma_f32_16x16x32_bf16 v[252:255], v[60:63], v[44:47], v[252:255]
  v_mfma_f32_16x16x32_bf16 v[248:251], v[56:59], v[44:47], v[248:251]
  v_mfma_f32_16x16x32_bf16 v[244:247], v[52:55], v[44:47], v[244:247]
  v_mfma_f32_16x16x32_bf16 v[240:243], v[48:51], v[44:47], v[240:243]
  ds_read_b128 v[16:19], v5 offset:0
  s_waitcnt lgkmcnt(0)
  v_mfma_f32_16x16x32_bf16 v[128:131], v[64:67], v[16:19], v[128:131]
  v_mfma_f32_16x16x32_bf16 v[132:135], v[68:71], v[16:19], v[132:135]
  v_mfma_f32_16x16x32_bf16 v[136:139], v[72:75], v[16:19], v[136:139]
  v_mfma_f32_16x16x32_bf16 v[140:143], v[76:79], v[16:19], v[140:143]
  ds_read_b128 v[20:23], v5 offset:2048
  s_waitcnt lgkmcnt(0)
  v_mfma_f32_16x16x32_bf16 v[156:159], v[76:79], v[20:23], v[156:159]
  v_mfma_f32_16x16x32_bf16 v[152:155], v[72:75], v[20:23], v[152:155]
  v_mfma_f32_16x16x32_bf16 v[148:151], v[68:71], v[20:23], v[148:151]
  v_mfma_f32_16x16x32_bf16 v[144:147], v[64:67], v[20:23], v[144:147]
  ds_read_b128 v[24:27], v5 offset:4096
  s_waitcnt lgkmcnt(0)
  v_mfma_f32_16x16x32_bf16 v[160:163], v[64:67], v[24:27], v[160:163]
  v_mfma_f32_16x16x32_bf16 v[164:167], v[68:71], v[24:27], v[164:167]
  v_mfma_f32_16x16x32_bf16 v[168:171], v[72:75], v[24:27], v[168:171]
  v_mfma_f32_16x16x32_bf16 v[172:175], v[76:79], v[24:27], v[172:175]
  ds_read_b128 v[28:31], v5 offset:6144
  s_waitcnt lgkmcnt(0)
  v_mfma_f32_16x16x32_bf16 v[188:191], v[76:79], v[28:31], v[188:191]
  v_mfma_f32_16x16x32_bf16 v[184:187], v[72:75], v[28:31], v[184:187]
  v_mfma_f32_16x16x32_bf16 v[180:183], v[68:71], v[28:31], v[180:183]
  v_mfma_f32_16x16x32_bf16 v[176:179], v[64:67], v[28:31], v[176:179]
  ds_read_b128 v[32:35], v5 offset:8192
  ds_read_b128 v[36:39], v5 offset:10240
  ds_read_b128 v[40:43], v5 offset:12288
  ds_read_b128 v[44:47], v5 offset:14336
  s_waitcnt lgkmcnt(3)
  s_waitcnt lgkmcnt(0)
  v_mfma_f32_16x16x32_bf16 v[192:195], v[64:67], v[32:35], v[192:195]
  s_add_u32 s57, s57, 49152
  s_cmp_eq_u32 s57, 147456
  s_cselect_b32 s57, 0, s57
  s_barrier
  v_add_u32 v6, s57, v10
  ds_read_b64_tr_b16 v[48:49], v6 offset:0
  v_mfma_f32_16x16x32_bf16 v[196:199], v[68:71], v[32:35], v[196:199]
  ds_read_b64_tr_b16 v[50:51], v6 offset:1024
  v_add_u32 v4, s57, v8
  v_mfma_f32_16x16x32_bf16 v[200:203], v[72:75], v[32:35], v[200:203]
  ds_read_b128 v[16:19], v4 offset:0
  v_add_u32 v7, s57, v11
  v_mfma_f32_16x16x32_bf16 v[204:207], v[76:79], v[32:35], v[204:207]
  ds_read_b64_tr_b16 v[52:53], v7 offset:0
  v_mfma_f32_16x16x32_bf16 v[220:223], v[76:79], v[36:39], v[220:223]
  ds_read_b64_tr_b16 v[54:55], v7 offset:1024
  v_add_u32 v5, s57, v9
  v_mfma_f32_16x16x32_bf16 v[216:219], v[72:75], v[36:39], v[216:219]
  ds_read_b64_tr_b16 v[56:57], v6 offset:16384
  v_mfma_f32_16x16x32_bf16 v[212:215], v[68:71], v[36:39], v[212:215]
  ds_read_b64_tr_b16 v[58:59], v6 offset:17408
  v_mfma_f32_16x16x32_bf16 v[208:211], v[64:67], v[36:39], v[208:211]
  ds_read_b64_tr_b16 v[60:61], v7 offset:16384
  v_mfma_f32_16x16x32_bf16 v[224:227], v[64:67], v[40:43], v[224:227]
  ds_read_b64_tr_b16 v[62:63], v7 offset:17408
  v_mfma_f32_16x16x32_bf16 v[228:231], v[68:71], v[40:43], v[228:231]
  v_mfma_f32_16x16x32_bf16 v[232:235], v[72:75], v[40:43], v[232:235]
  v_mfma_f32_16x16x32_bf16 v[236:239], v[76:79], v[40:43], v[236:239]
  v_mfma_f32_16x16x32_bf16 v[252:255], v[76:79], v[44:47], v[252:255]
  v_mfma_f32_16x16x32_bf16 v[248:251], v[72:75], v[44:47], v[248:251]
  v_mfma_f32_16x16x32_bf16 v[244:247], v[68:71], v[44:47], v[244:247]
  v_mfma_f32_16x16x32_bf16 v[240:243], v[64:67], v[44:47], v[240:243]
  s_waitcnt lgkmcnt(6)
  v_mfma_f32_16x16x32_bf16 v[128:131], v[48:51], v[16:19], v[128:131]
  s_waitcnt lgkmcnt(4)
  v_mfma_f32_16x16x32_bf16 v[132:135], v[52:55], v[16:19], v[132:135]
  s_waitcnt lgkmcnt(2)
  v_mfma_f32_16x16x32_bf16 v[136:139], v[56:59], v[16:19], v[136:139]
  s_waitcnt lgkmcnt(0)
  v_mfma_f32_16x16x32_bf16 v[140:143], v[60:63], v[16:19], v[140:143]
  ds_read_b128 v[20:23], v4 offset:2048
  s_waitcnt lgkmcnt(0)
  v_mfma_f32_16x16x32_bf16 v[156:159], v[60:63], v[20:23], v[156:159]
  v_mfma_f32_16x16x32_bf16 v[152:155], v[56:59], v[20:23], v[152:155]
  ds_read_b64_tr_b16 v[64:65], v6 offset:8192
  v_mfma_f32_16x16x32_bf16 v[148:151], v[52:55], v[20:23], v[148:151]
  v_mfma_f32_16x16x32_bf16 v[144:147], v[48:51], v[20:23], v[144:147]
  ds_read_b128 v[24:27], v4 offset:4096
  ds_read_b64_tr_b16 v[66:67], v6 offset:9216
  s_waitcnt lgkmcnt(1)
  v_mfma_f32_16x16x32_bf16 v[160:163], v[48:51], v[24:27], v[160:163]
  v_mfma_f32_16x16x32_bf16 v[164:167], v[52:55], v[24:27], v[164:167]
  ds_read_b64_tr_b16 v[68:69], v7 offset:8192
  v_mfma_f32_16x16x32_bf16 v[168:171], v[56:59], v[24:27], v[168:171]
  v_mfma_f32_16x16x32_bf16 v[172:175], v[60:63], v[24:27], v[172:175]
  ds_read_b128 v[28:31], v4 offset:6144
  ds_read_b64_tr_b16 v[70:71], v7 offset:9216
  s_waitcnt lgkmcnt(1)
  v_mfma_f32_16x16x32_bf16 v[188:191], v[60:63], v[28:31], v[188:191]
  v_mfma_f32_16x16x32_bf16 v[184:187], v[56:59], v[28:31], v[184:187]
  ds_read_b64_tr_b16 v[72:73], v6 offset:24576
  v_mfma_f32_16x16x32_bf16 v[180:183], v[52:55], v[28:31], v[180:183]
  v_mfma_f32_16x16x32_bf16 v[176:179], v[48:51], v[28:31], v[176:179]
  ds_read_b128 v[32:35], v4 offset:8192
  ds_read_b64_tr_b16 v[74:75], v6 offset:25600
  s_waitcnt lgkmcnt(1)
  v_mfma_f32_16x16x32_bf16 v[192:195], v[48:51], v[32:35], v[192:195]
  v_mfma_f32_16x16x32_bf16 v[196:199], v[52:55], v[32:35], v[196:199]
  ds_read_b64_tr_b16 v[76:77], v7 offset:24576
  v_mfma_f32_16x16x32_bf16 v[200:203], v[56:59], v[32:35], v[200:203]
  v_mfma_f32_16x16x32_bf16 v[204:207], v[60:63], v[32:35], v[204:207]
  ds_read_b128 v[36:39], v4 offset:10240
  ds_read_b64_tr_b16 v[78:79], v7 offset:25600
  s_waitcnt lgkmcnt(1)
  v_mfma_f32_16x16x32_bf16 v[220:223], v[60:63], v[36:39], v[220:223]
  v_mfma_f32_16x16x32_bf16 v[216:219], v[56:59], v[36:39], v[216:219]
  v_mfma_f32_16x16x32_bf16 v[212:215], v[52:55], v[36:39], v[212:215]
  v_mfma_f32_16x16x32_bf16 v[208:211], v[48:51], v[36:39], v[208:211]
  ds_read_b128 v[40:43], v4 offset:12288
  s_waitcnt lgkmcnt(0)
  v_mfma_f32_16x16x32_bf16 v[224:227], v[48:51], v[40:43], v[224:227]
  v_mfma_f32_16x16x32_bf16 v[228:231], v[52:55], v[40:43], v[228:231]
  v_mfma_f32_16x16x32_bf16 v[232:235], v[56:59], v[40:43], v[232:235]
  v_mfma_f32_16x16x32_bf16 v[236:239], v[60:63], v[40:43], v[236:239]
  ds_read_b128 v[44:47], v4 offset:14336
  s_waitcnt lgkmcnt(0)
  v_mfma_f32_16x16x32_bf16 v[252:255], v[60:63], v[44:47], v[252:255]
  v_mfma_f32_16x16x32_bf16 v[248:251], v[56:59], v[44:47], v[248:251]
  v_mfma_f32_16x16x32_bf16 v[244:247], v[52:55], v[44:47], v[244:247]
  v_mfma_f32_16x16x32_bf16 v[240:243], v[48:51], v[44:47], v[240:243]
  ds_read_b128 v[16:19], v5 offset:0
  s_waitcnt lgkmcnt(0)
  v_mfma_f32_16x16x32_bf16 v[128:131], v[64:67], v[16:19], v[128:131]
  v_mfma_f32_16x16x32_bf16 v[132:135], v[68:71], v[16:19], v[132:135]
  v_mfma_f32_16x16x32_bf16 v[136:139], v[72:75], v[16:19], v[136:139]
  v_mfma_f32_16x16x32_bf16 v[140:143], v[76:79], v[16:19], v[140:143]
  ds_read_b128 v[20:23], v5 offset:2048
  s_waitcnt lgkmcnt(0)
  v_mfma_f32_16x16x32_bf16 v[156:159], v[76:79], v[20:23], v[156:159]
  v_mfma_f32_16x16x32_bf16 v[152:155], v[72:75], v[20:23], v[152:155]
  v_mfma_f32_16x16x32_bf16 v[148:151], v[68:71], v[20:23], v[148:151]
  v_mfma_f32_16x16x32_bf16 v[144:147], v[64:67], v[20:23], v[144:147]
  ds_read_b128 v[24:27], v5 offset:4096
  s_waitcnt lgkmcnt(0)
  v_mfma_f32_16x16x32_bf16 v[160:163], v[64:67], v[24:27], v[160:163]
  v_mfma_f32_16x16x32_bf16 v[164:167], v[68:71], v[24:27], v[164:167]
  v_mfma_f32_16x16x32_bf16 v[168:171], v[72:75], v[24:27], v[168:171]
  v_mfma_f32_16x16x32_bf16 v[172:175], v[76:79], v[24:27], v[172:175]
  ds_read_b128 v[28:31], v5 offset:6144
  s_waitcnt lgkmcnt(0)
  v_mfma_f32_16x16x32_bf16 v[188:191], v[76:79], v[28:31], v[188:191]
  v_mfma_f32_16x16x32_bf16 v[184:187], v[72:75], v[28:31], v[184:187]
  v_mfma_f32_16x16x32_bf16 v[180:183], v[68:71], v[28:31], v[180:183]
  v_mfma_f32_16x16x32_bf16 v[176:179], v[64:67], v[28:31], v[176:179]
  ds_read_b128 v[32:35], v5 offset:8192
  ds_read_b128 v[36:39], v5 offset:10240
  ds_read_b128 v[40:43], v5 offset:12288
  ds_read_b128 v[44:47], v5 offset:14336
  s_waitcnt lgkmcnt(3)
  s_waitcnt lgkmcnt(0)
  v_mfma_f32_16x16x32_bf16 v[192:195], v[64:67], v[32:35], v[192:195]
  s_add_u32 s57, s57, 49152
  s_cmp_eq_u32 s57, 147456
  s_cselect_b32 s57, 0, s57
  s_barrier
  v_add_u32 v6, s57, v10
  ds_read_b64_tr_b16 v[48:49], v6 offset:0
  v_mfma_f32_16x16x32_bf16 v[196:199], v[68:71], v[32:35], v[196:199]
  ds_read_b64_tr_b16 v[50:51], v6 offset:1024
  v_add_u32 v4, s57, v8
  v_mfma_f32_16x16x32_bf16 v[200:203], v[72:75], v[32:35], v[200:203]
  ds_read_b128 v[16:19], v4 offset:0
  v_add_u32 v7, s57, v11
  v_mfma_f32_16x16x32_bf16 v[204:207], v[76:79], v[32:35], v[204:207]
  ds_read_b64_tr_b16 v[52:53], v7 offset:0
  v_mfma_f32_16x16x32_bf16 v[220:223], v[76:79], v[36:39], v[220:223]
  ds_read_b64_tr_b16 v[54:55], v7 offset:1024
  v_add_u32 v5, s57, v9
  v_mfma_f32_16x16x32_bf16 v[216:219], v[72:75], v[36:39], v[216:219]
  ds_read_b64_tr_b16 v[56:57], v6 offset:16384
  v_mfma_f32_16x16x32_bf16 v[212:215], v[68:71], v[36:39], v[212:215]
  ds_read_b64_tr_b16 v[58:59], v6 offset:17408
  v_mfma_f32_16x16x32_bf16 v[208:211], v[64:67], v[36:39], v[208:211]
  ds_read_b64_tr_b16 v[60:61], v7 offset:16384
  v_mfma_f32_16x16x32_bf16 v[224:227], v[64:67], v[40:43], v[224:227]
  ds_read_b64_tr_b16 v[62:63], v7 offset:17408
  v_mfma_f32_16x16x32_bf16 v[228:231], v[68:71], v[40:43], v[228:231]
  ds_read_b128 v[20:23], v4 offset:2048
  v_mfma_f32_16x16x32_bf16 v[232:235], v[72:75], v[40:43], v[232:235]
  ds_read_b128 v[24:27], v4 offset:4096
  v_mfma_f32_16x16x32_bf16 v[236:239], v[76:79], v[40:43], v[236:239]
  ds_read_b128 v[28:31], v4 offset:6144
  v_mfma_f32_16x16x32_bf16 v[252:255], v[76:79], v[44:47], v[252:255]
  ds_read_b128 v[32:35], v4 offset:8192
  v_mfma_f32_16x16x32_bf16 v[248:251], v[72:75], v[44:47], v[248:251]
  v_mfma_f32_16x16x32_bf16 v[244:247], v[68:71], v[44:47], v[244:247]
  v_mfma_f32_16x16x32_bf16 v[240:243], v[64:67], v[44:47], v[240:243]
  s_mov_b32 s58, 3
L_loop2:
  s_waitcnt lgkmcnt(10)
  v_mfma_f32_16x16x32_bf16 v[128:131], v[48:51], v[16:19], v[128:131]
  ds_read_b128 v[36:39], v4 offset:10240
  s_waitcnt lgkmcnt(9)
  v_mfma_f32_16x16x32_bf16 v[132:135], v[52:55], v[16:19], v[132:135]
  s_waitcnt lgkmcnt(7)
  v_mfma_f32_16x16x32_bf16 v[136:139], v[56:59], v[16:19], v[136:139]
  s_waitcnt lgkmcnt(5)
  v_mfma_f32_16x16x32_bf16 v[140:143], v[60:63], v[16:19], v[140:143]
  s_waitcnt lgkmcnt(4)
  v_mfma_f32_16x16x32_bf16 v[156:159], v[60:63], v[20:23], v[156:159]
  ds_read_b128 v[40:43], v4 offset:12288
  v_mfma_f32_16x16x32_bf16 v[152:155], v[56:59], v[20:23], v[152:155]
  ds_read_b64_tr_b16 v[64:65], v6 offset:8192
  v_mfma_f32_16x16x32_bf16 v[148:151], v[52:55], v[20:23], v[148:151]
  v_mfma_f32_16x16x32_bf16 v[144:147], v[48:51], v[20:23], v[144:147]
  ds_read_b64_tr_b16 v[66:67], v6 offset:9216
  s_waitcnt lgkmcnt(6)
  v_mfma_f32_16x16x32_bf16 v[160:163], v[48:51], v[24:27], v[160:163]
  ds_read_b128 v[44:47], v4 offset:14336
  v_mfma_f32_16x16x32_bf16 v[164:167], v[52:55], v[24:27], v[164:167]
  ds_read_b64_tr_b16 v[68:69], v7 offset:8192
  v_mfma_f32_16x16x32_bf16 v[168:171], v[56:59], v[24:27], v[168:171]
  v_mfma_f32_16x16x32_bf16 v[172:175], v[60:63], v[24:27], v[172:175]
  ds_read_b64_tr_b16 v[70:71], v7 offset:9216
  s_waitcnt lgkmcnt(8)
  v_mfma_f32_16x16x32_bf16 v[188:191], v[60:63], v[28:31], v[188:191]
  ds_read_b128 v[16:19], v5 offset:0
  v_mfma_f32_16x16x32_bf16 v[184:187], v[56:59], v[28:31], v[184:187]
  ds_read_b64_tr_b16 v[72:73], v6 offset:24576
  v_mfma_f32_16x16x32_bf16 v[180:183], v[52:55], v[28:31], v[180:183]
  v_mfma_f32_16x16x32_bf16 v[176:179], v[48:51], v[28:31], v[176:179]
  ds_read_b64_tr_b16 v[74:75], v6 offset:25600
  s_waitcnt lgkmcnt(10)
  v_mfma_f32_16x16x32_bf16 v[192:195], v[48:51], v[32:35], v[192:195]
  ds_read_b128 v[20:23], v5 offset:2048
  v_mfma_f32_16x16x32_bf16 v[196:199], v[52:55], v[32:35], v[196:199]
  ds_read_b64_tr_b16 v[76:77], v7 offset:24576
  v_mfma_f32_16x16x32_bf16 v[200:203], v[56:59], v[32:35], v[200:203]
  v_mfma_f32_16x16x32_bf16 v[204:207], v[60:63], v[32:35], v[204:207]
  ds_read_b64_tr_b16 v[78:79], v7 offset:25600
  s_waitcnt lgkmcnt(12)
  v_mfma_f32_16x16x32_bf16 v[220:223], v[60:63], v[36:39], v[220:223]
  ds_read_b128 v[24:27], v5 offset:4096
  v_mfma_f32_16x16x32_bf16 v[216:219], v[56:59], v[36:39], v[216:219]
  v_mfma_f32_16x16x32_bf16 v[212:215], v[52:55], v[36:39], v[212:215]
  v_mfma_f32_16x16x32_bf16 v[208:211], v[48:51], v[36:39], v[208:211]
  s_waitcnt lgkmcnt(12)
  v_mfma_f32_16x16x32_bf16 v[224:227], v[48:51], v[40:43], v[224:227]
  ds_read_b128 v[28:31], v5 offset:6144
  v_mfma_f32_16x16x32_bf16 v[228:231], v[52:55], v[40:43], v[228:231]
  v_mfma_f32_16x16x32_bf16 v[232:235], v[56:59], v[40:43], v[232:235]
  v_mfma_f32_16x16x32_bf16 v[236:239], v[60:63], v[40:43], v[236:239]
  s_waitcnt lgkmcnt(10)
  v_mfma_f32_16x16x32_bf16 v[252:255], v[60:63], v[44:47], v[252:255]
  ds_read_b128 v[32:35], v5 offset:8192
  v_mfma_f32_16x16x32_bf16 v[248:251], v[56:59], v[44:47], v[248:251]
  v_mfma_f32_16x16x32_bf16 v[244:247], v[52:55], v[44:47], v[244:247]
  v_mfma_f32_16x16x32_bf16 v[240:243], v[48:51], v[44:47], v[240:243]
  s_waitcnt lgkmcnt(8)
  v_mfma_f32_16x16x32_bf16 v[128:131], v[64:67], v[16:19], v[128:131]
  ds_read_b128 v[36:39], v5 offset:10240
  v_mfma_f32_16x16x32_bf16 v[132:135], v[68:71], v[16:19], v[132:135]
  s_waitcnt lgkmcnt(7)
  v_mfma_f32_16x16x32_bf16 v[136:139], v[72:75], v[16:19], v[136:139]
  s_waitcnt lgkmcnt(4)
  v_mfma_f32_16x16x32_bf16 v[140:143], v[76:79], v[16:19], v[140:143]
  v_mfma_f32_16x16x32_bf16 v[156:159], v[76:79], v[20:23], v[156:159]
  ds_read_b128 v[40:43], v5 offset:12288
  v_mfma_f32_16x16x32_bf16 v[152:155], v[72:75], v[20:23], v[152:155]
  v_mfma_f32_16x16x32_bf16 v[148:151], v[68:71], v[20:23], v[148:151]
  v_mfma_f32_16x16x32_bf16 v[144:147], v[64:67], v[20:23], v[144:147]
  s_waitcnt lgkmcnt(4)
  v_mfma_f32_16x16x32_bf16 v[160:163], v[64:67], v[24:27], v[160:163]
  ds_read_b128 v[44:47], v5 offset:14336
  v_mfma_f32_16x16x32_bf16 v[164:167], v[68:71], v[24:27], v[164:167]
  v_mfma_f32_16x16x32_bf16 v[168:171], v[72:75], v[24:27], v[168:171]
  v_mfma_f32_16x16x32_bf16 v[172:175], v[76:79], v[24:27], v[172:175]
  s_waitcnt lgkmcnt(4)
  v_mfma_f32_16x16x32_bf16 v[188:191], v[76:79], v[28:31], v[188:191]
  v_mfma_f32_16x16x32_bf16 v[184:187], v[72:75], v[28:31], v[184:187]
  v_mfma_f32_16x16x32_bf16 v[180:183], v[68:71], v[28:31], v[180:183]
  v_mfma_f32_16x16x32_bf16 v[176:179], v[64:67], v[28:31], v[176:179]
  s_waitcnt lgkmcnt(3)
  s_waitcnt lgkmcnt(0)
  v_mfma_f32_16x16x32_bf16 v[192:195], v[64:67], v[32:35], v[192:195]
  s_add_u32 s57, s57, 49152
  s_cmp_eq_u32 s57, 147456
  s_cselect_b32 s57, 0, s57
  s_barrier
  v_add_u32 v6, s57, v10
  ds_read_b64_tr_b16 v[48:49], v6 offset:0
  v_mfma_f32_16x16x32_bf16 v[196:199], v[68:71], v[32:35], v[196:199]
  ds_read_b64_tr_b16 v[50:51], v6 offset:1024
  v_add_u32 v4, s57, v8
  v_mfma_f32_16x16x32_bf16 v[200:203], v[72:75], v[32:35], v[200:203]
  ds_read_b128 v[16:19], v4 offset:0
  v_add_u32 v7, s57, v11
  v_mfma_f32_16x16x32_bf16 v[204:207], v[76:79], v[32:35], v[204:207]
  ds_read_b64_tr_b16 v[52:53], v7 offset:0
  v_mfma_f32_16x16x32_bf16 v[220:223], v[76:79], v[36:39], v[220:223]
  ds_read_b64_tr_b16 v[54:55], v7 offset:1024
  v_add_u32 v5, s57, v9
  v_mfma_f32_16x16x32_bf16 v[216:219], v[72:75], v[36:39], v[216:219]
  ds_read_b64_tr_b16 v[56:57], v6 offset:16384
  v_mfma_f32_16x16x32_bf16 v[212:215], v[68:71], v[36:39], v[212:215]
  ds_read_b64_tr_b16 v[58:59], v6 offset:17408
  v_mfma_f32_16x16x32_bf16 v[208:211], v[64:67], v[36:39], v[208:211]
  ds_read_b64_tr_b16 v[60:61], v7 offset:16384
  v_mfma_f32_16x16x32_bf16 v[224:227], v[64:67], v[40:43], v[224:227]
  ds_read_b64_tr_b16 v[62:63], v7 offset:17408
  v_mfma_f32_16x16x32_bf16 v[228:231], v[68:71], v[40:43], v[228:231]
  ds_read_b128 v[20:23], v4 offset:2048
  v_mfma_f32_16x16x32_bf16 v[232:235], v[72:75], v[40:43], v[232:235]
  ds_read_b128 v[24:27], v4 offset:4096
  v_mfma_f32_16x16x32_bf16 v[236:239], v[76:79], v[40:43], v[236:239]
  ds_read_b128 v[28:31], v4 offset:6144
  v_mfma_f32_16x16x32_bf16 v[252:255], v[76:79], v[44:47], v[252:255]
  ds_read_b128 v[32:35], v4 offset:8192
  v_mfma_f32_16x16x32_bf16 v[248:251], v[72:75], v[44:47], v[248:251]
  v_mfma_f32_16x16x32_bf16 v[244:247], v[68:71], v[44:47], v[244:247]
  s_sub_u32 s58, s58, 1
  s_cmp_lg_u32 s58, 0
  v_mfma_f32_16x16x32_bf16 v[240:243], v[64:67], v[44:47], v[240:243]
  s_cbranch_scc1 L_loop2
  s_waitcnt lgkmcnt(10)
  v_mfma_f32_16x16x32_bf16 v[128:131], v[48:51], v[16:19], v[128:131]
  v_add_u32 v10, 49152, v10
  ds_read_b128 v[36:39], v4 offset:10240
  s_waitcnt lgkmcnt(9)
  v_mfma_f32_16x16x32_bf16 v[132:135], v[52:55], v[16:19], v[132:135]
  ds_read_b64_tr_b16 v[64:65], v6 offset:8192
  s_waitcnt lgkmcnt(8)
  v_mfma_f32_16x16x32_bf16 v[136:139], v[56:59], v[16:19], v[136:139]
  v_add_u32 v11, 49152, v11
  ds_read_b64_tr_b16 v[66:67], v6 offset:9216
  s_waitcnt lgkmcnt(7)
  v_mfma_f32_16x16x32_bf16 v[140:143], v[60:63], v[16:19], v[140:143]
  ds_read_b64_tr_b16 v[68:69], v7 offset:8192
  s_waitcnt lgkmcnt(7)
  v_mfma_f32_16x16x32_bf16 v[144:147], v[48:51], v[20:23], v[144:147]
  ds_read_b128 v[40:43], v4 offset:12288
  v_mfma_f32_16x16x32_bf16 v[148:151], v[52:55], v[20:23], v[148:151]
  ds_read_b64_tr_b16 v[70:71], v7 offset:9216
  v_mfma_f32_16x16x32_bf16 v[152:155], v[56:59], v[20:23], v[152:155]
  ds_read_b64_tr_b16 v[72:73], v6 offset:24576
  v_mfma_f32_16x16x32_bf16 v[156:159], v[60:63], v[20:23], v[156:159]
  ds_read_b64_tr_b16 v[74:75], v6 offset:25600
  s_waitcnt lgkmcnt(10)
  v_mfma_f32_16x16x32_bf16 v[160:163], v[48:51], v[24:27], v[160:163]
  ds_read_b128 v[44:47], v4 offset:14336
  v_mfma_f32_16x16x32_bf16 v[164:167], v[52:55], v[24:27], v[164:167]
  ds_read_b64_tr_b16 v[76:77], v7 offset:24576
  v_mfma_f32_16x16x32_bf16 v[168:171], v[56:59], v[24:27], v[168:171]
  ds_read_b64_tr_b16 v[78:79], v7 offset:25600
  v_mfma_f32_16x16x32_bf16 v[172:175], v[60:63], v[24:27], v[172:175]
  s_waitcnt lgkmcnt(12)
  v_mfma_f32_16x16x32_bf16 v[176:179], v[48:51], v[28:31], v[176:179]
  ds_read_b128 v[16:19], v5 offset:0
  v_mfma_f32_16x16x32_bf16 v[180:183], v[52:55], v[28:31], v[180:183]
  v_mfma_f32_16x16x32_bf16 v[184:187], v[56:59], v[28:31], v[184:187]
  v_mfma_f32_16x16x32_bf16 v[188:191], v[60:63], v[28:31], v[188:191]
  s_barrier
  s_waitcnt lgkmcnt(12)
  v_mfma_f32_16x16x32_bf16 v[192:195], v[48:51], v[32:35], v[192:195]
  ds_read_b128 v[20:23], v4 offset:49152
  v_mfma_f32_16x16x32_bf16 v[196:199], v[52:55], v[32:35], v[196:199]
  ds_read_b64_tr_b16 v[80:81], v10 offset:0
  v_mfma_f32_16x16x32_bf16 v[200:203], v[56:59], v[32:35], v[200:203]
  ds_read_b64_tr_b16 v[82:83], v10 offset:1024
  v_mfma_f32_16x16x32_bf16 v[204:207], v[60:63], v[32:35], v[204:207]
  ds_read_b64_tr_b16 v[84:85], v11 offset:0
  s_waitcnt lgkmcnt(15)
  v_mfma_f32_16x16x32_bf16 v[208:211], v[48:51], v[36:39], v[208:211]
  ds_read_b128 v[24:27], v5 offset:49152
  v_mfma_f32_16x16x32_bf16 v[212:215], v[52:55], v[36:39], v[212:215]
  ds_read_b64_tr_b16 v[86:87], v11 offset:1024
  v_mfma_f32_16x16x32_bf16 v[216:219], v[56:59], v[36:39], v[216:219]
  ds_read_b64_tr_b16 v[88:89], v10 offset:16384
  v_mfma_f32_16x16x32_bf16 v[220:223], v[60:63], v[36:39], v[220:223]
  ds_read_b64_tr_b16 v[90:91], v10 offset:17408
  s_waitcnt lgkmcnt(15)
  v_mfma_f32_16x16x32_bf16 v[224:227], v[48:51], v[40:43], v[224:227]
  ds_read_b128 v[28:31], v5 offset:2048
  v_mfma_f32_16x16x32_bf16 v[228:231], v[52:55], v[40:43], v[228:231]
  ds_read_b64_tr_b16 v[92:93], v11 offset:16384
  v_mfma_f32_16x16x32_bf16 v[232:235], v[56:59], v[40:43], v[232:235]
  ds_read_b64_tr_b16 v[94:95], v11 offset:17408
  v_mfma_f32_16x16x32_bf16 v[236:239], v[60:63], v[40:43], v[236:239]
  ds_read_b64_tr_b16 v[96:97], v10 offset:8192
  s_waitcnt lgkmcnt(15)
  v_mfma_f32_16x16x32_bf16 v[240:243], v[48:51], v[44:47], v[240:243]
  ds_read_b128 v[32:35], v4 offset:51200
  v_mfma_f32_16x16x32_bf16 v[244:247], v[52:55], v[44:47], v[244:247]
  ds_read_b64_tr_b16 v[98:99], v10 offset:9216
  v_mfma_f32_16x16x32_bf16 v[248:251], v[56:59], v[44:47], v[248:251]
  ds_read_b64_tr_b16 v[100:101], v11 offset:8192
  v_mfma_f32_16x16x32_bf16 v[252:255], v[60:63], v[44:47], v[252:255]
  ds_read_b64_tr_b16 v[102:103], v11 offset:9216
  s_waitcnt lgkmcnt(15)
  v_mfma_f32_16x16x32_bf16 v[128:131], v[64:67], v[16:19], v[128:131]
  ds_read_b128 v[36:39], v5 offset:51200
  v_mfma_f32_16x16x32_bf16 v[132:135], v[68:71], v[16:19], v[132:135]
  ds_read_b64_tr_b16 v[104:105], v10 offset:24576
  v_mfma_f32_16x16x32_bf16 v[136:139], v[72:75], v[16:19], v[136:139]
  ds_read_b64_tr_b16 v[106:107], v10 offset:25600
  v_mfma_f32_16x16x32_bf16 v[140:143], v[76:79], v[16:19], v[140:143]
  ds_read_b64_tr_b16 v[108:109], v11 offset:24576
  s_waitcnt lgkmcnt(15)
  v_mfma_f32_16x16x32_bf16 v[128:131], v[80:83], v[20:23], v[128:131]
  ds_read_b128 v[40:43], v5 offset:4096
  s_waitcnt lgkmcnt(15)
  v_mfma_f32_16x16x32_bf16 v[132:135], v[84:87], v[20:23], v[132:135]
  ds_read_b64_tr_b16 v[110:111], v11 offset:25600
  s_waitcnt lgkmcnt(14)
  v_mfma_f32_16x16x32_bf16 v[136:139], v[88:91], v[20:23], v[136:139]
  s_waitcnt lgkmcnt(11)
  v_mfma_f32_16x16x32_bf16 v[140:143], v[92:95], v[20:23], v[140:143]
  s_waitcnt lgkmcnt(8)
  v_mfma_f32_16x16x32_bf16 v[128:131], v[96:99], v[24:27], v[128:131]
  ds_read_b128 v[44:47], v4 offset:53248
  s_waitcnt lgkmcnt(7)
  v_mfma_f32_16x16x32_bf16 v[132:135], v[100:103], v[24:27], v[132:135]
  s_waitcnt lgkmcnt(4)
  v_mfma_f32_16x16x32_bf16 v[136:139], v[104:107], v[24:27], v[136:139]
  s_waitcnt lgkmcnt(1)
  v_mfma_f32_16x16x32_bf16 v[140:143], v[108:111], v[24:27], v[140:143]
  v_mfma_f32_16x16x32_bf16 v[144:147], v[64:67], v[28:31], v[144:147]
  ds_read_b128 v[16:19], v5 offset:53248
  s_mov_b64 exec, 1
  ds_add_u32 v113, v114 offset:16
  s_mov_b64 exec, -1
  v_mfma_f32_16x16x32_bf16 v[148:151], v[68:71], v[28:31], v[148:151]
  v_mfma_f32_16x16x32_bf16 v[152:155], v[72:75], v[28:31], v[152:155]
  v_max_f32 v128, 0, v128
  v_max_f32 v129, 0, v129
  v_mul_f32 v128, v128, v136
  v_mfma_f32_16x16x32_bf16 v[156:159], v[76:79], v[28:31], v[156:159]
  v_mul_f32 v129, v129, v137
  v_cvt_pk_bf16_f32 v128, v128, v129
  v_mfma_f32_16x16x32_bf16 v[144:147], v[80:83], v[32:35], v[144:147]
  ds_read_b128 v[20:23], v5 offset:6144
  v_max_f32 v130, 0, v130
  v_max_f32 v131, 0, v131
  v_mfma_f32_16x16x32_bf16 v[148:151], v[84:87], v[32:35], v[148:151]
  v_mul_f32 v130, v130, v138
  v_mul_f32 v131, v131, v139
  v_mfma_f32_16x16x32_bf16 v[152:155], v[88:91], v[32:35], v[152:155]
  v_cvt_pk_bf16_f32 v129, v130, v131
  v_max_f32 v132, 0, v132
  v_mfma_f32_16x16x32_bf16 v[156:159], v[92:95], v[32:35], v[156:159]
  v_max_f32 v133, 0, v133
  v_mul_f32 v132, v132, v140
  v_mfma_f32_16x16x32_bf16 v[144:147], v[96:99], v[36:39], v[144:147]
  ds_read_b128 v[24:27], v4 offset:55296
  v_mul_f32 v133, v133, v141
  v_cvt_pk_bf16_f32 v130, v132, v133
  v_mfma_f32_16x16x32_bf16 v[148:151], v[100:103], v[36:39], v[148:151]
  v_max_f32 v134, 0, v134
  v_max_f32 v135, 0, v135
  v_mfma_f32_16x16x32_bf16 v[152:155], v[104:107], v[36:39], v[152:155]
  v_mul_f32 v134, v134, v142
  v_mul_f32 v135, v135, v143
  v_mfma_f32_16x16x32_bf16 v[156:159], v[108:111], v[36:39], v[156:159]
  v_cvt_pk_bf16_f32 v131, v134, v135
  buffer_store_dwordx4 v[128:131], v112, s[20:23], s64 offen offset:0 sc1
  v_mfma_f32_16x16x32_bf16 v[160:163], v[64:67], v[40:43], v[160:163]
  ds_read_b128 v[28:31], v5 offset:55296
  v_mfma_f32_16x16x32_bf16 v[164:167], v[68:71], v[40:43], v[164:167]
  v_mfma_f32_16x16x32_bf16 v[168:171], v[72:75], v[40:43], v[168:171]
  v_max_f32 v144, 0, v144
  v_max_f32 v145, 0, v145
  v_mul_f32 v144, v144, v152
  v_mfma_f32_16x16x32_bf16 v[172:175], v[76:79], v[40:43], v[172:175]
  v_mul_f32 v145, v145, v153
  v_cvt_pk_bf16_f32 v132, v144, v145
  s_waitcnt lgkmcnt(5)
  v_mfma_f32_16x16x32_bf16 v[160:163], v[80:83], v[44:47], v[160:163]
  ds_read_b128 v[32:35], v5 offset:8192
  v_max_f32 v146, 0, v146
  v_max_f32 v147, 0, v147
  v_mfma_f32_16x16x32_bf16 v[164:167], v[84:87], v[44:47], v[164:167]
  v_mul_f32 v146, v146, v154
  v_mul_f32 v147, v147, v155
  v_mfma_f32_16x16x32_bf16 v[168:171], v[88:91], v[44:47], v[168:171]
  v_cvt_pk_bf16_f32 v133, v146, v147
  v_max_f32 v148, 0, v148
  v_mfma_f32_16x16x32_bf16 v[172:175], v[92:95], v[44:47], v[172:175]
  v_max_f32 v149, 0, v149
  v_mul_f32 v148, v148, v156
  s_waitcnt lgkmcnt(5)
  v_mfma_f32_16x16x32_bf16 v[160:163], v[96:99], v[16:19], v[160:163]
  ds_read_b128 v[36:39], v4 offset:57344
  v_mul_f32 v149, v149, v157
  v_cvt_pk_bf16_f32 v134, v148, v149
  v_mfma_f32_16x16x32_bf16 v[164:167], v[100:103], v[16:19], v[164:167]
  v_max_f32 v150, 0, v150
  v_max_f32 v151, 0, v151
  v_mfma_f32_16x16x32_bf16 v[168:171], v[104:107], v[16:19], v[168:171]
  v_mul_f32 v150, v150, v158
  v_mul_f32 v151, v151, v159
  v_mfma_f32_16x16x32_bf16 v[172:175], v[108:111], v[16:19], v[172:175]
  v_cvt_pk_bf16_f32 v135, v150, v151
  buffer_store_dwordx4 v[132:135], v112, s[20:23], s64 offen offset:1024 sc1
  s_waitcnt lgkmcnt(4)
  v_mfma_f32_16x16x32_bf16 v[176:179], v[64:67], v[20:23], v[176:179]
  ds_read_b128 v[40:43], v5 offset:57344
  v_mfma_f32_16x16x32_bf16 v[180:183], v[68:71], v[20:23], v[180:183]
  v_mfma_f32_16x16x32_bf16 v[184:187], v[72:75], v[20:23], v[184:187]
  v_max_f32 v160, 0, v160
  v_max_f32 v161, 0, v161
  v_mul_f32 v160, v160, v168
  v_mfma_f32_16x16x32_bf16 v[188:191], v[76:79], v[20:23], v[188:191]
  v_mul_f32 v161, v161, v169
  v_cvt_pk_bf16_f32 v136, v160, v161
  s_waitcnt lgkmcnt(4)
  v_mfma_f32_16x16x32_bf16 v[176:179], v[80:83], v[24:27], v[176:179]
  ds_read_b128 v[44:47], v5 offset:10240
  v_max_f32 v162, 0, v162
  v_max_f32 v163, 0, v163
  v_mfma_f32_16x16x32_bf16 v[180:183], v[84:87], v[24:27], v[180:183]
  v_mul_f32 v162, v162, v170
  v_mul_f32 v163, v163, v171
  v_mfma_f32_16x16x32_bf16 v[184:187], v[88:91], v[24:27], v[184:187]
  v_cvt_pk_bf16_f32 v137, v162, v163
  v_max_f32 v164, 0, v164
  v_mfma_f32_16x16x32_bf16 v[188:191], v[92:95], v[24:27], v[188:191]
  v_max_f32 v165, 0, v165
  v_mul_f32 v164, v164, v172
  s_waitcnt lgkmcnt(4)
  v_mfma_f32_16x16x32_bf16 v[176:179], v[96:99], v[28:31], v[176:179]
  ds_read_b128 v[16:19], v4 offset:59392
  v_mul_f32 v165, v165, v173
  v_cvt_pk_bf16_f32 v138, v164, v165
  v_mfma_f32_16x16x32_bf16 v[180:183], v[100:103], v[28:31], v[180:183]
  v_max_f32 v166, 0, v166
  v_max_f32 v167, 0, v167
  v_mfma_f32_16x16x32_bf16 v[184:187], v[104:107], v[28:31], v[184:187]
  v_mul_f32 v166, v166, v174
  v_mul_f32 v167, v167, v175
  v_mfma_f32_16x16x32_bf16 v[188:191], v[108:111], v[28:31], v[188:191]
  v_cvt_pk_bf16_f32 v139, v166, v167
  buffer_store_dwordx4 v[136:139], v112, s[20:23], s64 offen offset:2048 sc1
  s_waitcnt lgkmcnt(4)
  v_mfma_f32_16x16x32_bf16 v[192:195], v[64:67], v[32:35], v[192:195]
  ds_read_b128 v[20:23], v5 offset:59392
  v_mfma_f32_16x16x32_bf16 v[196:199], v[68:71], v[32:35], v[196:199]
  v_mfma_f32_16x16x32_bf16 v[200:203], v[72:75], v[32:35], v[200:203]
  v_max_f32 v176, 0, v176
  v_max_f32 v177, 0, v177
  v_mul_f32 v176, v176, v184
  v_mfma_f32_16x16x32_bf16 v[204:207], v[76:79], v[32:35], v[204:207]
  v_mul_f32 v177, v177, v185
  v_cvt_pk_bf16_f32 v140, v176, v177
  s_waitcnt lgkmcnt(4)
  v_mfma_f32_16x16x32_bf16 v[192:195], v[80:83], v[36:39], v[192:195]
  ds_read_b128 v[24:27], v5 offset:12288
  v_max_f32 v178, 0, v178
  v_max_f32 v179, 0, v179
  v_mfma_f32_16x16x32_bf16 v[196:199], v[84:87], v[36:39], v[196:199]
  v_mul_f32 v178, v178, v186
  v_mul_f32 v179, v179, v187
  v_mfma_f32_16x16x32_bf16 v[200:203], v[88:91], v[36:39], v[200:203]
  v_cvt_pk_bf16_f32 v141, v178, v179
  v_max_f32 v180, 0, v180
  v_mfma_f32_16x16x32_bf16 v[204:207], v[92:95], v[36:39], v[204:207]
  v_max_f32 v181, 0, v181
  v_mul_f32 v180, v180, v188
  s_waitcnt lgkmcnt(4)
  v_mfma_f32_16x16x32_bf16 v[192:195], v[96:99], v[40:43], v[192:195]
  ds_read_b128 v[28:31], v4 offset:61440
  v_mul_f32 v181, v181, v189
  v_cvt_pk_bf16_f32 v142, v180, v181
  v_mfma_f32_16x16x32_bf16 v[196:199], v[100:103], v[40:43], v[196:199]
  v_max_f32 v182, 0, v182
  v_max_f32 v183, 0, v183
  v_mfma_f32_16x16x32_bf16 v[200:203], v[104:107], v[40:43], v[200:203]
  v_mul_f32 v182, v182, v190
  v_mul_f32 v183, v183, v191
  v_mfma_f32_16x16x32_bf16 v[204:207], v[108:111], v[40:43], v[204:207]
  v_cvt_pk_bf16_f32 v143, v182, v183
  buffer_store_dwordx4 v[140:143], v112, s[20:23], s64 offen offset:3072 sc1
  s_waitcnt lgkmcnt(4)
  v_mfma_f32_16x16x32_bf16 v[208:211], v[64:67], v[44:47], v[208:211]
  ds_read_b128 v[32:35], v5 offset:61440
  v_mfma_f32_16x16x32_bf16 v[212:215], v[68:71], v[44:47], v[212:215]
  v_mfma_f32_16x16x32_bf16 v[216:219], v[72:75], v[44:47], v[216:219]
  v_max_f32 v192, 0, v192
  v_max_f32 v193, 0, v193
  v_mul_f32 v192, v192, v200
  v_mfma_f32_16x16x32_bf16 v[220:223], v[76:79], v[44:47], v[220:223]
  v_mul_f32 v193, v193, v201
  v_cvt_pk_bf16_f32 v160, v192, v193
  s_waitcnt lgkmcnt(4)
  v_mfma_f32_16x16x32_bf16 v[208:211], v[80:83], v[16:19], v[208:211]
  ds_read_b128 v[36:39], v5 offset:14336
  v_max_f32 v194, 0, v194
  v_max_f32 v195, 0, v195
  v_mfma_f32_16x16x32_bf16 v[212:215], v[84:87], v[16:19], v[212:215]
  v_mul_f32 v194, v194, v202
  v_mul_f32 v195, v195, v203
  v_mfma_f32_16x16x32_bf16 v[216:219], v[88:91], v[16:19], v[216:219]
  v_cvt_pk_bf16_f32 v161, v194, v195
  v_max_f32 v196, 0, v196
  v_mfma_f32_16x16x32_bf16 v[220:223], v[92:95], v[16:19], v[220:223]
  v_max_f32 v197, 0, v197
  v_mul_f32 v196, v196, v204
  s_waitcnt lgkmcnt(4)
  v_mfma_f32_16x16x32_bf16 v[208:211], v[96:99], v[20:23], v[208:211]
  ds_read_b128 v[40:43], v4 offset:63488
  v_mul_f32 v197, v197, v205
  v_cvt_pk_bf16_f32 v162, v196, v197
  v_mfma_f32_16x16x32_bf16 v[212:215], v[100:103], v[20:23], v[212:215]
  v_max_f32 v198, 0, v198
  v_max_f32 v199, 0, v199
  v_mfma_f32_16x16x32_bf16 v[216:219], v[104:107], v[20:23], v[216:219]
  v_mul_f32 v198, v198, v206
  v_mul_f32 v199, v199, v207
  v_mfma_f32_16x16x32_bf16 v[220:223], v[108:111], v[20:23], v[220:223]
  v_cvt_pk_bf16_f32 v163, v198, v199
  buffer_store_dwordx4 v[160:163], v112, s[20:23], s65 offen offset:0 sc1
  s_waitcnt lgkmcnt(4)
  v_mfma_f32_16x16x32_bf16 v[224:227], v[64:67], v[24:27], v[224:227]
  ds_read_b128 v[44:47], v5 offset:63488
  v_mfma_f32_16x16x32_bf16 v[228:231], v[68:71], v[24:27], v[228:231]
  v_mfma_f32_16x16x32_bf16 v[232:235], v[72:75], v[24:27], v[232:235]
  v_max_f32 v208, 0, v208
  v_max_f32 v209, 0, v209
  v_mul_f32 v208, v208, v216
  v_mfma_f32_16x16x32_bf16 v[236:239], v[76:79], v[24:27], v[236:239]
  v_mul_f32 v209, v209, v217
  v_cvt_pk_bf16_f32 v164, v208, v209
  s_waitcnt lgkmcnt(4)
  v_mfma_f32_16x16x32_bf16 v[224:227], v[80:83], v[28:31], v[224:227]
  v_max_f32 v210, 0, v210
  v_max_f32 v211, 0, v211
  v_mfma_f32_16x16x32_bf16 v[228:231], v[84:87], v[28:31], v[228:231]
  v_mul_f32 v210, v210, v218
  v_mul_f32 v211, v211, v219
  v_mfma_f32_16x16x32_bf16 v[232:235], v[88:91], v[28:31], v[232:235]
  v_cvt_pk_bf16_f32 v165, v210, v211
  v_max_f32 v212, 0, v212
  v_mfma_f32_16x16x32_bf16 v[236:239], v[92:95], v[28:31], v[236:239]
  v_max_f32 v213, 0, v213
  v_mul_f32 v212, v212, v220
  s_waitcnt lgkmcnt(3)
  v_mfma_f32_16x16x32_bf16 v[224:227], v[96:99], v[32:35], v[224:227]
  v_mul_f32 v213, v213, v221
  v_cvt_pk_bf16_f32 v166, v212, v213
  v_mfma_f32_16x16x32_bf16 v[228:231], v[100:103], v[32:35], v[228:231]
  v_max_f32 v214, 0, v214
  v_max_f32 v215, 0, v215
  v_mfma_f32_16x16x32_bf16 v[232:235], v[104:107], v[32:35], v[232:235]
  v_mul_f32 v214, v214, v222
  v_mul_f32 v215, v215, v223
  v_mfma_f32_16x16x32_bf16 v[236:239], v[108:111], v[32:35], v[236:239]
  v_cvt_pk_bf16_f32 v167, v214, v215
  buffer_store_dwordx4 v[164:167], v112, s[20:23], s65 offen offset:1024 sc1
  s_waitcnt lgkmcnt(2)
  v_mfma_f32_16x16x32_bf16 v[240:243], v[64:67], v[36:39], v[240:243]
  v_mfma_f32_16x16x32_bf16 v[244:247], v[68:71], v[36:39], v[244:247]
  v_mfma_f32_16x16x32_bf16 v[248:251], v[72:75], v[36:39], v[248:251]
  v_max_f32 v224, 0, v224
  v_max_f32 v225, 0, v225
  v_mul_f32 v224, v224, v232
  v_mfma_f32_16x16x32_bf16 v[252:255], v[76:79], v[36:39], v[252:255]
  v_mul_f32 v225, v225, v233
  v_cvt_pk_bf16_f32 v168, v224, v225
  s_waitcnt lgkmcnt(1)
  v_mfma_f32_16x16x32_bf16 v[240:243], v[80:83], v[40:43], v[240:243]
  v_max_f32 v226, 0, v226
  v_max_f32 v227, 0, v227
  v_mfma_f32_16x16x32_bf16 v[244:247], v[84:87], v[40:43], v[244:247]
  v_mul_f32 v226, v226, v234
  v_mul_f32 v227, v227, v235
  v_mfma_f32_16x16x32_bf16 v[248:251], v[88:91], v[40:43], v[248:251]
  v_cvt_pk_bf16_f32 v169, v226, v227
  v_max_f32 v228, 0, v228
  v_mfma_f32_16x16x32_bf16 v[252:255], v[92:95], v[40:43], v[252:255]
  v_max_f32 v229, 0, v229
  v_mul_f32 v228, v228, v236
  s_waitcnt lgkmcnt(0)
  v_mfma_f32_16x16x32_bf16 v[240:243], v[96:99], v[44:47], v[240:243]
  v_mul_f32 v229, v229, v237
  v_cvt_pk_bf16_f32 v170, v228, v229
  v_mfma_f32_16x16x32_bf16 v[244:247], v[100:103], v[44:47], v[244:247]
  v_max_f32 v230, 0, v230
  v_max_f32 v231, 0, v231
  v_mfma_f32_16x16x32_bf16 v[248:251], v[104:107], v[44:47], v[248:251]
  v_mul_f32 v230, v230, v238
  v_mul_f32 v231, v231, v239
  v_mfma_f32_16x16x32_bf16 v[252:255], v[108:111], v[44:47], v[252:255]
  v_cvt_pk_bf16_f32 v171, v230, v231
  buffer_store_dwordx4 v[168:171], v112, s[20:23], s65 offen offset:2048 sc1
  v_max_f32 v240, 0, v240
  v_max_f32 v241, 0, v241
  s_nop 3
  v_mul_f32 v240, v240, v248
  v_mul_f32 v241, v241, v249
  v_cvt_pk_bf16_f32 v172, v240, v241
  v_max_f32 v242, 0, v242
  v_max_f32 v243, 0, v243
  v_mul_f32 v242, v242, v250
  v_mul_f32 v243, v243, v251
  v_cvt_pk_bf16_f32 v173, v242, v243
  v_max_f32 v244, 0, v244
  v_max_f32 v245, 0, v245
  v_mul_f32 v244, v244, v252
  v_mul_f32 v245, v245, v253
  v_cvt_pk_bf16_f32 v174, v244, v245
  v_max_f32 v246, 0, v246
  v_max_f32 v247, 0, v247
  v_mul_f32 v246, v246, v254
  v_mul_f32 v247, v247, v255
  v_cvt_pk_bf16_f32 v175, v246, v247
  buffer_store_dwordx4 v[172:175], v112, s[20:23], s65 offen offset:3072 sc1
  v_mov_b32 v2, s82
  s_mov_b32 s63, 0x800000
  s_mov_b64 exec, 1
W15:
  ds_read_b32 v1, v2 offset:16
  s_sub_u32 s63, s63, 1
  s_cbranch_scc1 WX15
  s_waitcnt lgkmcnt(0)
  v_cmp_gt_u32 vcc, 4, v1
  s_nop 0
  s_cbranch_vccnz W15
WX15:
  s_mov_b64 exec, -1
  s_add_u32 m0, s88, 0
  s_add_u32 s86, s85, 3
  s_sub_u32 s92, s86, 7
  s_cselect_b32 s86, s86, s92
  s_lshl_b32 s86, s86, 17
  buffer_load_dwordx4 v116, s[24:27], s86 offen offset:0 lds
  buffer_load_dwordx4 v117, s[24:27], s86 offen offset:1024 lds
  buffer_load_dwordx4 v118, s[24:27], s86 offen offset:2048 lds
  buffer_load_dwordx4 v119, s[24:27], s86 offen offset:3072 lds
  s_add_u32 m0, s88, 4096
  s_add_u32 s86, s85, 4
  s_sub_u32 s92, s86, 7
  s_cselect_b32 s86, s86, s92
  s_lshl_b32 s86, s86, 17
  buffer_load_dwordx4 v116, s[24:27], s86 offen offset:0 lds
  buffer_load_dwordx4 v117, s[24:27], s86 offen offset:1024 lds
  buffer_load_dwordx4 v118, s[24:27], s86 offen offset:2048 lds
  buffer_load_dwordx4 v119, s[24:27], s86 offen offset:3072 lds
L_bpart:
  v_mov_b32 v2, s82
  v_mov_b32 v1, 1
  s_mov_b64 exec, 1
  ds_add_u32 v2, v1 offset:12
  s_mov_b64 exec, -1
  v_lshrrev_b32 v1, 2, v0
  v_lshlrev_b32 v2, 7, v1
  v_bfe_u32 v1, v0, 3, 2
  v_lshl_add_u32 v2, v1, 5, v2
  v_and_b32 v1, 3, v0
  v_lshl_add_u32 v2, v1, 3, v2
  v_add_u32 v176, s87, v2
  v_add_u32 v180, s88, v2
  v_lshlrev_b32 v184, 4, v0
  s_lshl_b32 s70, s54, 2
  s_add_u32 s70, s70, s49
  s_lshl_b32 s70, s70, 8
  v_xor_b32 v177, 32, v176
  v_xor_b32 v181, 32, v180
  v_xor_b32 v178, 64, v176
  v_xor_b32 v182, 64, v180
  v_xor_b32 v179, 96, v176
  v_xor_b32 v183, 96, v180
  s_lshl_b32 s56, s49, 12
  s_mul_i32 s55, s52, 114688
  s_add_u32 s56, s56, s55
  s_mul_i32 s67, s54, 229632
  s_add_u32 s67, s67, s56
  v_add_u32 v185, s67, v184
  s_xor_b32 s67, s54, 1
  s_mul_i32 s67, s67, 229632
  s_add_u32 s67, s67, s56
  v_add_u32 v184, s67, v184
  v_mov_b32 v186, s82
  v_mov_b32 v187, 1
  v_and_b32 v1, 15, v0
  v_lshrrev_b32 v2, 5, v0
  v_and_b32 v5, 7, v0
  v_xor_b32 v6, v2, v5
  v_lshlrev_b32 v6, 4, v6
  v_lshl_add_u32 v6, v1, 7, v6
  v_bfe_u32 v1, v0, 4, 1
  v_lshl_add_u32 v6, v1, 3, v6
  v_add_u32 v6, s88, v6
  v_xor_b32 v7, 32, v6
  v_xor_b32 v8, 64, v6
  v_xor_b32 v9, 96, v6
  v_mul_u32_u24 v10, 6, v2
  v_add_lshl_u32 v10, v10, v1, 13
  v_lshl_add_u32 v11, v1, 1, v2
  v_bfe_u32 v1, v0, 3, 1
  v_lshl_add_u32 v11, v11, 1, v1
  v_lshlrev_b32 v11, 10, v11
  v_lshl_add_u32 v11, v5, 4, v11
  v_xor_b32 v5, v5, v1
  v_lshl_add_u32 v10, v5, 4, v10
  s_lshl_b32 s92, s48, 3
  v_add_u32 v1, s92, v1
  v_lshl_add_u32 v10, v1, 7, v10
  v_lshl_add_u32 v1, v2, 1, v1
  v_lshlrev_b32 v1, 2, v1
  v_add_u32 v5, 156224, v1
  s_lshl_b32 s93, s54, 3
  s_add_u32 s93, s93, s48
  s_lshl_b32 s93, s93, 13
  s_lshl_b32 s92, s84, 7
  s_add_u32 s93, s93, s92
  v_and_b32 v1, 1, v0
  v_lshlrev_b32 v1, 4, v1
  v_mov_b32 v2, 0x3f80
  v_lshlrev_b32 v2, v1, v2
  v_bfe_u32 v1, v0, 1, 3
  v_cmp_eq_u32 s[60:61], 0, v1
  v_cmp_eq_u32 s[62:63], 1, v1
  s_nop 0
  v_cndmask_b32 v188, 0, v2, s[60:61]
  v_cmp_eq_u32 s[60:61], 2, v1
  v_cndmask_b32 v189, 0, v2, s[62:63]
  v_cmp_eq_u32 s[62:63], 3, v1
  v_cndmask_b32 v190, 0, v2, s[60:61]
  v_cmp_eq_u32 s[60:61], 4, v1
  v_cndmask_b32 v191, 0, v2, s[62:63]
  v_cmp_eq_u32 s[62:63], 5, v1
  v_cndmask_b32 v12, 0, v2, s[60:61]
  v_cmp_eq_u32 s[60:61], 6, v1
  v_cndmask_b32 v13, 0, v2, s[62:63]
  v_cmp_eq_u32 s[62:63], 7, v1
  v_cndmask_b32 v14, 0, v2, s[60:61]
  s_nop 0
  v_cndmask_b32 v15, 0, v2, s[62:63]
  v_lshlrev_b32 v4, 4, v0
  s_lshl_b32 s64, s2, 2
  s_add_u32 s64, s64, s49
  s_lshl_b32 s64, s64, 11
  s_add_u32 s64, s64, 18874368
  s_lshl_b32 s65, s2, 8
  s_add_u32 s65, s65, 49152
  s_lshl_b32 s66, s49, 10
  s_cmp_eq_u32 s51, 7
  s_cbranch_scc1 L_nofh
  s_waitcnt vmcnt(8)
  s_atomic_add s81, s[6:7], s70
  s_add_u32 m0, s88, 16384
  s_add_u32 s86, s85, 5
  s_sub_u32 s92, s86, 7
  s_cselect_b32 s86, s86, s92
  s_lshl_b32 s86, s86, 17
  buffer_load_dwordx4 v116, s[24:27], s86 offen offset:0 lds
  buffer_load_dwordx4 v117, s[24:27], s86 offen offset:1024 lds
  buffer_load_dwordx4 v118, s[24:27], s86 offen offset:2048 lds
  buffer_load_dwordx4 v119, s[24:27], s86 offen offset:3072 lds
  s_add_u32 m0, s88, 20480
  s_add_u32 s86, s85, 6
  s_sub_u32 s92, s86, 7
  s_cselect_b32 s86, s86, s92
  s_lshl_b32 s86, s86, 17
  buffer_load_dwordx4 v116, s[24:27], s86 offen offset:0 lds
  buffer_load_dwordx4 v117, s[24:27], s86 offen offset:1024 lds
  buffer_load_dwordx4 v118, s[24:27], s86 offen offset:2048 lds
  buffer_load_dwordx4 v119, s[24:27], s86 offen offset:3072 lds
L_nofh:
  v_mov_b32 v2, s82
  s_mov_b32 s63, 0x800000
  s_mov_b64 exec, 1
W16:
  ds_read_b32 v1, v2 offset:28
  s_sub_u32 s63, s63, 1
  s_cbranch_scc1 WX16
  s_waitcnt lgkmcnt(0)
  v_cmp_gt_u32 vcc, 4, v1
  s_nop 0
  s_cbranch_vccz WX16
  s_sleep 1
  s_branch W16
WX16:
  s_mov_b64 exec, -1
  s_mov_b32 s95, 0
  s_atomic_add s95, s[6:7], s70 glc
  ds_read_b64_tr_b16 v[16:17], v176 offset:0
  ds_read_b64_tr_b16 v[18:19], v176 offset:2048
  ds_read_b64_tr_b16 v[20:21], v177 offset:0
  ds_read_b64_tr_b16 v[22:23], v177 offset:2048
  ds_read_b64_tr_b16 v[24:25], v178 offset:0
  ds_read_b64_tr_b16 v[26:27], v178 offset:2048
  ds_read_b64_tr_b16 v[28:29], v179 offset:0
  ds_read_b64_tr_b16 v[30:31], v179 offset:2048
  ds_read_b64_tr_b16 v[32:33], v176 offset:4096
  ds_read_b64_tr_b16 v[34:35], v176 offset:6144
  ds_read_b64_tr_b16 v[36:37], v177 offset:4096
  ds_read_b64_tr_b16 v[38:39], v177 offset:6144
  ds_read_b64_tr_b16 v[40:41], v178 offset:4096
  ds_read_b64_tr_b16 v[42:43], v178 offset:6144
  ds_read_b64_tr_b16 v[44:45], v179 offset:4096
  ds_read_b64_tr_b16 v[46:47], v179 offset:6144
  ds_read_b64_tr_b16 v[48:49], v176 offset:8192
  ds_read_b64_tr_b16 v[50:51], v176 offset:10240
  ds_read_b64_tr_b16 v[52:53], v177 offset:8192
  ds_read_b64_tr_b16 v[54:55], v177 offset:10240
  ds_read_b64_tr_b16 v[56:57], v178 offset:8192
  ds_read_b64_tr_b16 v[58:59], v178 offset:10240
  ds_read_b64_tr_b16 v[60:61], v179 offset:8192
  ds_read_b64_tr_b16 v[62:63], v179 offset:10240
  s_cmp_eq_u32 s51, 7
  s_cbranch_scc1 R_own
  s_waitcnt lgkmcnt(15)
  v_mfma_f32_16x16x32_bf16 v[192:195], v[16:19], v[128:131], 0
  v_mfma_f32_16x16x32_bf16 v[208:211], v[20:23], v[128:131], 0
  v_mfma_f32_16x16x32_bf16 v[224:227], v[24:27], v[128:131], 0
  v_mfma_f32_16x16x32_bf16 v[240:243], v[28:31], v[128:131], 0
  v_mfma_f32_16x16x32_bf16 v[196:199], v[16:19], v[132:135], 0
  v_mfma_f32_16x16x32_bf16 v[212:215], v[20:23], v[132:135], 0
  v_mfma_f32_16x16x32_bf16 v[228:231], v[24:27], v[132:135], 0
  v_mfma_f32_16x16x32_bf16 v[244:247], v[28:31], v[132:135], 0
  v_mfma_f32_16x16x32_bf16 v[200:203], v[16:19], v[136:139], 0
  v_mfma_f32_16x16x32_bf16 v[216:219], v[20:23], v[136:139], 0
  v_mfma_f32_16x16x32_bf16 v[232:235], v[24:27], v[136:139], 0
  v_mfma_f32_16x16x32_bf16 v[248:251], v[28:31], v[136:139], 0
  v_mfma_f32_16x16x32_bf16 v[204:207], v[16:19], v[140:143], 0
  v_mfma_f32_16x16x32_bf16 v[220:223], v[20:23], v[140:143], 0
  v_mfma_f32_16x16x32_bf16 v[236:239], v[24:27], v[140:143], 0
  v_mfma_f32_16x16x32_bf16 v[252:255], v[28:31], v[140:143], 0
  s_waitcnt lgkmcnt(0)
  s_cmp_ge_u32 s95, 7
  s_cbranch_scc1 SX18
  s_mov_b32 s63, 0x80000
SP18:
  s_mov_b32 s62, 0
  s_atomic_add s62, s[6:7], s70 glc
  s_waitcnt lgkmcnt(0)
  s_cmp_ge_u32 s62, 7
  s_cbranch_scc1 SX18
  s_sub_u32 s63, s63, 1
  s_cbranch_scc1 SX18
  s_sleep 2
  s_branch SP18
SX18:
  s_add_u32 s60, s85, 1
  s_sub_u32 s92, s60, 7
  s_cselect_b32 s60, s60, s92
  s_lshl_b32 s60, s60, 14
  buffer_load_dwordx4 v[144:147], v184, s[20:23], s60 offen offset:0 sc1
  buffer_load_dwordx4 v[148:151], v184, s[20:23], s60 offen offset:1024 sc1
  buffer_load_dwordx4 v[152:155], v184, s[20:23], s60 offen offset:2048 sc1
  buffer_load_dwordx4 v[156:159], v184, s[20:23], s60 offen offset:3072 sc1
  s_add_u32 s60, s85, 2
  s_sub_u32 s92, s60, 7
  s_cselect_b32 s60, s60, s92
  s_lshl_b32 s60, s60, 14
  buffer_load_dwordx4 v[128:131], v184, s[20:23], s60 offen offset:0 sc1
  buffer_load_dwordx4 v[132:135], v184, s[20:23], s60 offen offset:1024 sc1
  buffer_load_dwordx4 v[136:139], v184, s[20:23], s60 offen offset:2048 sc1
  buffer_load_dwordx4 v[140:143], v184, s[20:23], s60 offen offset:3072 sc1
L_own:
  s_waitcnt vmcnt(20)
  ds_read_b64_tr_b16 v[64:65], v180 offset:0
  ds_read_b64_tr_b16 v[66:67], v180 offset:2048
  ds_read_b64_tr_b16 v[68:69], v181 offset:0
  ds_read_b64_tr_b16 v[70:71], v181 offset:2048
  ds_read_b64_tr_b16 v[72:73], v182 offset:0
  ds_read_b64_tr_b16 v[74:75], v182 offset:2048
  ds_read_b64_tr_b16 v[76:77], v183 offset:0
  ds_read_b64_tr_b16 v[78:79], v183 offset:2048
  s_waitcnt vmcnt(16)
  ds_read_b64_tr_b16 v[80:81], v180 offset:4096
  ds_read_b64_tr_b16 v[82:83], v180 offset:6144
  ds_read_b64_tr_b16 v[84:85], v181 offset:4096
  ds_read_b64_tr_b16 v[86:87], v181 offset:6144
  ds_read_b64_tr_b16 v[88:89], v182 offset:4096
  ds_read_b64_tr_b16 v[90:91], v182 offset:6144
  ds_read_b64_tr_b16 v[92:93], v183 offset:4096
  ds_read_b64_tr_b16 v[94:95], v183 offset:6144
  s_waitcnt vmcnt(12)
  ds_read_b64_tr_b16 v[96:97], v180 offset:16384
  ds_read_b64_tr_b16 v[98:99], v180 offset:18432
  ds_read_b64_tr_b16 v[100:101], v181 offset:16384
  ds_read_b64_tr_b16 v[102:103], v181 offset:18432
  ds_read_b64_tr_b16 v[104:105], v182 offset:16384
  ds_read_b64_tr_b16 v[106:107], v182 offset:18432
  ds_read_b64_tr_b16 v[108:109], v183 offset:16384
  ds_read_b64_tr_b16 v[110:111], v183 offset:18432
  s_waitcnt vmcnt(8)
  ds_read_b64_tr_b16 v[112:113], v180 offset:20480
  ds_read_b64_tr_b16 v[114:115], v180 offset:22528
  ds_read_b64_tr_b16 v[116:117], v181 offset:20480
  ds_read_b64_tr_b16 v[118:119], v181 offset:22528
  ds_read_b64_tr_b16 v[120:121], v182 offset:20480
  ds_read_b64_tr_b16 v[122:123], v182 offset:22528
  ds_read_b64_tr_b16 v[124:125], v183 offset:20480
  ds_read_b64_tr_b16 v[126:127], v183 offset:22528
  s_waitcnt lgkmcnt(15)
  s_waitcnt vmcnt(7)
  v_mfma_f32_16x16x32_bf16 v[192:195], v[32:35], v[144:147], v[192:195]
  v_mfma_f32_16x16x32_bf16 v[208:211], v[36:39], v[144:147], v[208:211]
  v_mfma_f32_16x16x32_bf16 v[224:227], v[40:43], v[144:147], v[224:227]
  v_mfma_f32_16x16x32_bf16 v[240:243], v[44:47], v[144:147], v[240:243]
  s_add_u32 s60, s85, 3
  s_sub_u32 s92, s60, 7
  s_cselect_b32 s60, s60, s92
  s_lshl_b32 s60, s60, 14
  buffer_load_dwordx4 v[144:147], v184, s[20:23], s60 offen offset:0 sc1
  s_waitcnt vmcnt(7)
  v_mfma_f32_16x16x32_bf16 v[196:199], v[32:35], v[148:151], v[196:199]
  v_mfma_f32_16x16x32_bf16 v[212:215], v[36:39], v[148:151], v[212:215]
  v_mfma_f32_16x16x32_bf16 v[228:231], v[40:43], v[148:151], v[228:231]
  v_mfma_f32_16x16x32_bf16 v[244:247], v[44:47], v[148:151], v[244:247]
  buffer_load_dwordx4 v[148:151], v184, s[20:23], s60 offen offset:1024 sc1
  s_waitcnt vmcnt(7)
  v_mfma_f32_16x16x32_bf16 v[200:203], v[32:35], v[152:155], v[200:203]
  v_mfma_f32_16x16x32_bf16 v[216:219], v[36:39], v[152:155], v[216:219]
  v_mfma_f32_16x16x32_bf16 v[232:235], v[40:43], v[152:155], v[232:235]
  v_mfma_f32_16x16x32_bf16 v[248:251], v[44:47], v[152:155], v[248:251]
  buffer_load_dwordx4 v[152:155], v184, s[20:23], s60 offen offset:2048 sc1
  s_waitcnt vmcnt(7)
  v_mfma_f32_16x16x32_bf16 v[204:207], v[32:35], v[156:159], v[204:207]
  v_mfma_f32_16x16x32_bf16 v[220:223], v[36:39], v[156:159], v[220:223]
  v_mfma_f32_16x16x32_bf16 v[236:239], v[40:43], v[156:159], v[236:239]
  v_mfma_f32_16x16x32_bf16 v[252:255], v[44:47], v[156:159], v[252:255]
  buffer_load_dwordx4 v[156:159], v184, s[20:23], s60 offen offset:3072 sc1
  s_waitcnt vmcnt(7)
  v_mfma_f32_16x16x32_bf16 v[192:195], v[48:51], v[128:131], v[192:195]
  v_mfma_f32_16x16x32_bf16 v[208:211], v[52:55], v[128:131], v[208:211]
  v_mfma_f32_16x16x32_bf16 v[224:227], v[56:59], v[128:131], v[224:227]
  v_mfma_f32_16x16x32_bf16 v[240:243], v[60:63], v[128:131], v[240:243]
  s_add_u32 s60, s85, 4
  s_sub_u32 s92, s60, 7
  s_cselect_b32 s60, s60, s92
  s_lshl_b32 s60, s60, 14
  buffer_load_dwordx4 v[128:131], v184, s[20:23], s60 offen offset:0 sc1
  s_waitcnt vmcnt(7)
  v_mfma_f32_16x16x32_bf16 v[196:199], v[48:51], v[132:135], v[196:199]
  v_mfma_f32_16x16x32_bf16 v[212:215], v[52:55], v[132:135], v[212:215]
  v_mfma_f32_16x16x32_bf16 v[228:231], v[56:59], v[132:135], v[228:231]
  v_mfma_f32_16x16x32_bf16 v[244:247], v[60:63], v[132:135], v[244:247]
  buffer_load_dwordx4 v[132:135], v184, s[20:23], s60 offen offset:1024 sc1
  s_waitcnt vmcnt(7)
  v_mfma_f32_16x16x32_bf16 v[200:203], v[48:51], v[136:139], v[200:203]
  v_mfma_f32_16x16x32_bf16 v[216:219], v[52:55], v[136:139], v[216:219]
  v_mfma_f32_16x16x32_bf16 v[232:235], v[56:59], v[136:139], v[232:235]
  v_mfma_f32_16x16x32_bf16 v[248:251], v[60:63], v[136:139], v[248:251]
  buffer_load_dwordx4 v[136:139], v184, s[20:23], s60 offen offset:2048 sc1
  s_waitcnt vmcnt(7)
  v_mfma_f32_16x16x32_bf16 v[204:207], v[48:51], v[140:143], v[204:207]
  v_mfma_f32_16x16x32_bf16 v[220:223], v[52:55], v[140:143], v[220:223]
  v_mfma_f32_16x16x32_bf16 v[236:239], v[56:59], v[140:143], v[236:239]
  v_mfma_f32_16x16x32_bf16 v[252:255], v[60:63], v[140:143], v[252:255]
  buffer_load_dwordx4 v[140:143], v184, s[20:23], s60 offen offset:3072 sc1
  s_waitcnt vmcnt(7)
  v_mfma_f32_16x16x32_bf16 v[192:195], v[64:67], v[144:147], v[192:195]
  v_mfma_f32_16x16x32_bf16 v[208:211], v[68:71], v[144:147], v[208:211]
  v_mfma_f32_16x16x32_bf16 v[224:227], v[72:75], v[144:147], v[224:227]
  v_mfma_f32_16x16x32_bf16 v[240:243], v[76:79], v[144:147], v[240:243]
  s_add_u32 s60, s85, 5
  s_sub_u32 s92, s60, 7
  s_cselect_b32 s60, s60, s92
  s_lshl_b32 s60, s60, 14
  buffer_load_dwordx4 v[144:147], v184, s[20:23], s60 offen offset:0 sc1
  s_waitcnt vmcnt(7)
  v_mfma_f32_16x16x32_bf16 v[196:199], v[64:67], v[148:151], v[196:199]
  v_mfma_f32_16x16x32_bf16 v[212:215], v[68:71], v[148:151], v[212:215]
  v_mfma_f32_16x16x32_bf16 v[228:231], v[72:75], v[148:151], v[228:231]
  v_mfma_f32_16x16x32_bf16 v[244:247], v[76:79], v[148:151], v[244:247]
  buffer_load_dwordx4 v[148:151], v184, s[20:23], s60 offen offset:1024 sc1
  s_waitcnt vmcnt(7)
  v_mfma_f32_16x16x32_bf16 v[200:203], v[64:67], v[152:155], v[200:203]
  v_mfma_f32_16x16x32_bf16 v[216:219], v[68:71], v[152:155], v[216:219]
  v_mfma_f32_16x16x32_bf16 v[232:235], v[72:75], v[152:155], v[232:235]
  v_mfma_f32_16x16x32_bf16 v[248:251], v[76:79], v[152:155], v[248:251]
  buffer_load_dwordx4 v[152:155], v184, s[20:23], s60 offen offset:2048 sc1
  s_waitcnt vmcnt(7)
  v_mfma_f32_16x16x32_bf16 v[204:207], v[64:67], v[156:159], v[204:207]
  v_mfma_f32_16x16x32_bf16 v[220:223], v[68:71], v[156:159], v[220:223]
  v_mfma_f32_16x16x32_bf16 v[236:239], v[72:75], v[156:159], v[236:239]
  v_mfma_f32_16x16x32_bf16 v[252:255], v[76:79], v[156:159], v[252:255]
  buffer_load_dwordx4 v[156:159], v184, s[20:23], s60 offen offset:3072 sc1
  s_waitcnt vmcnt(7)
  v_mfma_f32_16x16x32_bf16 v[192:195], v[80:83], v[128:131], v[192:195]
  v_mfma_f32_16x16x32_bf16 v[208:211], v[84:87], v[128:131], v[208:211]
  v_mfma_f32_16x16x32_bf16 v[224:227], v[88:91], v[128:131], v[224:227]
  v_mfma_f32_16x16x32_bf16 v[240:243], v[92:95], v[128:131], v[240:243]
  s_add_u32 s60, s85, 6
  s_sub_u32 s92, s60, 7
  s_cselect_b32 s60, s60, s92
  s_lshl_b32 s60, s60, 14
  buffer_load_dwordx4 v[128:131], v184, s[20:23], s60 offen offset:0 sc1
  s_waitcnt vmcnt(7)
  v_mfma_f32_16x16x32_bf16 v[196:199], v[80:83], v[132:135], v[196:199]
  v_mfma_f32_16x16x32_bf16 v[212:215], v[84:87], v[132:135], v[212:215]
  v_mfma_f32_16x16x32_bf16 v[228:231], v[88:91], v[132:135], v[228:231]
  v_mfma_f32_16x16x32_bf16 v[244:247], v[92:95], v[132:135], v[244:247]
  buffer_load_dwordx4 v[132:135], v184, s[20:23], s60 offen offset:1024 sc1
  s_waitcnt vmcnt(7)
  v_mfma_f32_16x16x32_bf16 v[200:203], v[80:83], v[136:139], v[200:203]
  v_mfma_f32_16x16x32_bf16 v[216:219], v[84:87], v[136:139], v[216:219]
  v_mfma_f32_16x16x32_bf16 v[232:235], v[88:91], v[136:139], v[232:235]
  v_mfma_f32_16x16x32_bf16 v[248:251], v[92:95], v[136:139], v[248:251]
  buffer_load_dwordx4 v[136:139], v184, s[20:23], s60 offen offset:2048 sc1
  s_waitcnt vmcnt(7)
  v_mfma_f32_16x16x32_bf16 v[204:207], v[80:83], v[140:143], v[204:207]
  v_mfma_f32_16x16x32_bf16 v[220:223], v[84:87], v[140:143], v[220:223]
  v_mfma_f32_16x16x32_bf16 v[236:239], v[88:91], v[140:143], v[236:239]
  v_mfma_f32_16x16x32_bf16 v[252:255], v[92:95], v[140:143], v[252:255]
  buffer_load_dwordx4 v[140:143], v184, s[20:23], s60 offen offset:3072 sc1
  s_waitcnt lgkmcnt(8)
  s_waitcnt vmcnt(7)
  v_mfma_f32_16x16x32_bf16 v[192:195], v[96:99], v[144:147], v[192:195]
  v_mfma_f32_16x16x32_bf16 v[208:211], v[100:103], v[144:147], v[208:211]
  v_mfma_f32_16x16x32_bf16 v[224:227], v[104:107], v[144:147], v[224:227]
  v_mfma_f32_16x16x32_bf16 v[240:243], v[108:111], v[144:147], v[240:243]
  s_add_u32 s60, s85, 1
  s_sub_u32 s92, s60, 7
  s_cselect_b32 s60, s60, s92
  s_lshl_b32 s60, s60, 14
  buffer_load_dwordx4 v[144:147], v185, s[20:23], s60 offen offset:0 sc1
  s_waitcnt vmcnt(7)
  v_mfma_f32_16x16x32_bf16 v[196:199], v[96:99], v[148:151], v[196:199]
  v_mfma_f32_16x16x32_bf16 v[212:215], v[100:103], v[148:151], v[212:215]
  v_mfma_f32_16x16x32_bf16 v[228:231], v[104:107], v[148:151], v[228:231]
  v_mfma_f32_16x16x32_bf16 v[244:247], v[108:111], v[148:151], v[244:247]
  buffer_load_dwordx4 v[148:151], v185, s[20:23], s60 offen offset:1024 sc1
  s_waitcnt vmcnt(7)
  v_mfma_f32_16x16x32_bf16 v[200:203], v[96:99], v[152:155], v[200:203]
  v_mfma_f32_16x16x32_bf16 v[216:219], v[100:103], v[152:155], v[216:219]
  v_mfma_f32_16x16x32_bf16 v[232:235], v[104:107], v[152:155], v[232:235]
  v_mfma_f32_16x16x32_bf16 v[248:251], v[108:111], v[152:155], v[248:251]
  buffer_load_dwordx4 v[152:155], v185, s[20:23], s60 offen offset:2048 sc1
  s_waitcnt vmcnt(7)
  v_mfma_f32_16x16x32_bf16 v[204:207], v[96:99], v[156:159], v[204:207]
  v_mfma_f32_16x16x32_bf16 v[220:223], v[100:103], v[156:159], v[220:223]
  v_mfma_f32_16x16x32_bf16 v[236:239], v[104:107], v[156:159], v[236:239]
  v_mfma_f32_16x16x32_bf16 v[252:255], v[108:111], v[156:159], v[252:255]
  buffer_load_dwordx4 v[156:159], v185, s[20:23], s60 offen offset:3072 sc1
  s_waitcnt lgkmcnt(0)
  s_waitcnt vmcnt(7)
  v_mfma_f32_16x16x32_bf16 v[192:195], v[112:115], v[128:131], v[192:195]
  v_mfma_f32_16x16x32_bf16 v[208:211], v[116:119], v[128:131], v[208:211]
  v_mfma_f32_16x16x32_bf16 v[224:227], v[120:123], v[128:131], v[224:227]
  v_mfma_f32_16x16x32_bf16 v[240:243], v[124:127], v[128:131], v[240:243]
  s_add_u32 s60, s85, 2
  s_sub_u32 s92, s60, 7
  s_cselect_b32 s60, s60, s92
  s_lshl_b32 s60, s60, 14
  buffer_load_dwordx4 v[128:131], v185, s[20:23], s60 offen offset:0 sc1
  s_waitcnt vmcnt(7)
  v_mfma_f32_16x16x32_bf16 v[196:199], v[112:115], v[132:135], v[196:199]
  v_mfma_f32_16x16x32_bf16 v[212:215], v[116:119], v[132:135], v[212:215]
  v_cvt_pk_bf16_f32 v192, v192, v193
  v_cvt_pk_bf16_f32 v193, v194, v195
  ds_write_b64 v6, v[192:193] offset:16384
  v_cvt_pk_bf16_f32 v208, v208, v209
  v_mfma_f32_16x16x32_bf16 v[228:231], v[120:123], v[132:135], v[228:231]
  v_cvt_pk_bf16_f32 v209, v210, v211
  ds_write_b64 v7, v[208:209] offset:16384
  v_cvt_pk_bf16_f32 v224, v224, v225
  v_cvt_pk_bf16_f32 v225, v226, v227
  v_mfma_f32_16x16x32_bf16 v[244:247], v[124:127], v[132:135], v[244:247]
  ds_write_b64 v8, v[224:225] offset:16384
  v_cvt_pk_bf16_f32 v240, v240, v241
  v_cvt_pk_bf16_f32 v241, v242, v243
  ds_write_b64 v9, v[240:241] offset:16384
  buffer_load_dwordx4 v[132:135], v185, s[20:23], s60 offen offset:1024 sc1
  s_waitcnt vmcnt(7)
  v_mfma_f32_16x16x32_bf16 v[200:203], v[112:115], v[136:139], v[200:203]
  v_mfma_f32_16x16x32_bf16 v[216:219], v[116:119], v[136:139], v[216:219]
  v_cvt_pk_bf16_f32 v196, v196, v197
  v_cvt_pk_bf16_f32 v197, v198, v199
  ds_write_b64 v6, v[196:197] offset:18432
  v_cvt_pk_bf16_f32 v212, v212, v213
  v_mfma_f32_16x16x32_bf16 v[232:235], v[120:123], v[136:139], v[232:235]
  v_cvt_pk_bf16_f32 v213, v214, v215
  ds_write_b64 v7, v[212:213] offset:18432
  v_cvt_pk_bf16_f32 v228, v228, v229
  v_cvt_pk_bf16_f32 v229, v230, v231
  v_mfma_f32_16x16x32_bf16 v[248:251], v[124:127], v[136:139], v[248:251]
  ds_write_b64 v8, v[228:229] offset:18432
  v_cvt_pk_bf16_f32 v244, v244, v245
  v_cvt_pk_bf16_f32 v245, v246, v247
  ds_write_b64 v9, v[244:245] offset:18432
  buffer_load_dwordx4 v[136:139], v185, s[20:23], s60 offen offset:2048 sc1
  s_waitcnt vmcnt(7)
  v_mfma_f32_16x16x32_bf16 v[204:207], v[112:115], v[140:143], v[204:207]
  v_mfma_f32_16x16x32_bf16 v[220:223], v[116:119], v[140:143], v[220:223]
  v_cvt_pk_bf16_f32 v200, v200, v201
  v_cvt_pk_bf16_f32 v201, v202, v203
  ds_write_b64 v6, v[200:201] offset:20480
  v_cvt_pk_bf16_f32 v216, v216, v217
  v_mfma_f32_16x16x32_bf16 v[236:239], v[120:123], v[140:143], v[236:239]
  v_cvt_pk_bf16_f32 v217, v218, v219
  ds_write_b64 v7, v[216:217] offset:20480
  v_cvt_pk_bf16_f32 v232, v232, v233
  v_cvt_pk_bf16_f32 v233, v234, v235
  v_mfma_f32_16x16x32_bf16 v[252:255], v[124:127], v[140:143], v[252:255]
  ds_write_b64 v8, v[232:233] offset:20480
  v_cvt_pk_bf16_f32 v248, v248, v249
  v_cvt_pk_bf16_f32 v249, v250, v251
  ds_write_b64 v9, v[248:249] offset:20480
  buffer_load_dwordx4 v[140:143], v185, s[20:23], s60 offen offset:3072 sc1
  v_mfma_f32_16x16x32_bf16 v[192:195], v[16:19], v[160:163], 0
  v_mfma_f32_16x16x32_bf16 v[208:211], v[20:23], v[160:163], 0
  v_cvt_pk_bf16_f32 v204, v204, v205
  v_cvt_pk_bf16_f32 v205, v206, v207
  ds_write_b64 v6, v[204:205] offset:22528
  v_cvt_pk_bf16_f32 v220, v220, v221
  v_mfma_f32_16x16x32_bf16 v[224:227], v[24:27], v[160:163], 0
  v_cvt_pk_bf16_f32 v221, v222, v223
  ds_write_b64 v7, v[220:221] offset:22528
  v_cvt_pk_bf16_f32 v236, v236, v237
  v_cvt_pk_bf16_f32 v237, v238, v239
  v_mfma_f32_16x16x32_bf16 v[240:243], v[28:31], v[160:163], 0
  ds_write_b64 v8, v[236:237] offset:22528
  v_cvt_pk_bf16_f32 v252, v252, v253
  v_cvt_pk_bf16_f32 v253, v254, v255
  ds_write_b64 v9, v[252:253] offset:22528
  s_mov_b64 exec, 1
  ds_add_u32 v186, v187 offset:36
  s_mov_b64 exec, -1
  v_mfma_f32_16x16x32_bf16 v[196:199], v[16:19], v[164:167], 0
  v_mfma_f32_16x16x32_bf16 v[212:215], v[20:23], v[164:167], 0
  v_mfma_f32_16x16x32_bf16 v[228:231], v[24:27], v[164:167], 0
  v_mfma_f32_16x16x32_bf16 v[244:247], v[28:31], v[164:167], 0
  v_mfma_f32_16x16x32_bf16 v[200:203], v[16:19], v[168:171], 0
  v_mfma_f32_16x16x32_bf16 v[216:219], v[20:23], v[168:171], 0
  v_mfma_f32_16x16x32_bf16 v[232:235], v[24:27], v[168:171], 0
  v_mfma_f32_16x16x32_bf16 v[248:251], v[28:31], v[168:171], 0
  v_mfma_f32_16x16x32_bf16 v[204:207], v[16:19], v[172:175], 0
  v_mfma_f32_16x16x32_bf16 v[220:223], v[20:23], v[172:175], 0
  v_mfma_f32_16x16x32_bf16 v[236:239], v[24:27], v[172:175], 0
  v_mfma_f32_16x16x32_bf16 v[252:255], v[28:31], v[172:175], 0
  v_mov_b32 v2, s82
  s_mov_b32 s63, 0x800000
  s_mov_b64 exec, 1
W19:
  ds_read_b32 v1, v2 offset:36
  s_sub_u32 s63, s63, 1
  s_cbranch_scc1 WX19
  s_waitcnt lgkmcnt(0)
  v_cmp_gt_u32 vcc, 4, v1
  s_nop 0
  s_cbranch_vccnz W19
WX19:
  s_mov_b64 exec, -1
  v_add_u32 v1, s66, v10
  v_xor_b32 v2, 32, v1
  ds_read_b128 v[160:163], v1 offset:32768
  ds_read_b128 v[164:167], v2 offset:33024
  v_xor_b32 v1, 64, v1
  v_xor_b32 v2, 64, v2
  ds_read_b128 v[168:171], v1 offset:33280
  ds_read_b128 v[172:175], v2 offset:33536
  s_waitcnt vmcnt(7)
  v_mfma_f32_16x16x32_bf16 v[192:195], v[32:35], v[144:147], v[192:195]
  v_mfma_f32_16x16x32_bf16 v[208:211], v[36:39], v[144:147], v[208:211]
  v_mfma_f32_16x16x32_bf16 v[224:227], v[40:43], v[144:147], v[224:227]
  v_mfma_f32_16x16x32_bf16 v[240:243], v[44:47], v[144:147], v[240:243]
  s_add_u32 s60, s85, 3
  s_sub_u32 s92, s60, 7
  s_cselect_b32 s60, s60, s92
  s_lshl_b32 s60, s60, 14
  buffer_load_dwordx4 v[144:147], v185, s[20:23], s60 offen offset:0 sc1
  s_waitcnt lgkmcnt(0)
  v_mfma_f32_16x16x32_bf16 v[176:179], v[188:191], v[160:163], 0
  v_mfma_f32_16x16x32_bf16 v[180:183], v[188:191], v[168:171], 0
  v_mfma_f32_16x16x32_bf16 v[176:179], v[12:15], v[164:167], v[176:179]
  v_mfma_f32_16x16x32_bf16 v[180:183], v[12:15], v[172:175], v[180:183]
  v_add_u32 v1, s66, v10
  v_xor_b32 v2, 32, v1
  ds_read_b128 v[160:163], v1 offset:33792
  ds_read_b128 v[164:167], v2 offset:34048
  v_xor_b32 v1, 64, v1
  v_xor_b32 v2, 64, v2
  ds_read_b128 v[168:171], v1 offset:34304
  ds_read_b128 v[172:175], v2 offset:34560
  s_waitcnt vmcnt(7)
  v_mfma_f32_16x16x32_bf16 v[196:199], v[32:35], v[148:151], v[196:199]
  v_mfma_f32_16x16x32_bf16 v[212:215], v[36:39], v[148:151], v[212:215]
  v_mfma_f32_16x16x32_bf16 v[228:231], v[40:43], v[148:151], v[228:231]
  v_mfma_f32_16x16x32_bf16 v[244:247], v[44:47], v[148:151], v[244:247]
  buffer_load_dwordx4 v[148:151], v185, s[20:23], s60 offen offset:1024 sc1
  v_cvt_pk_bf16_f32 v176, v176, v177
  v_cvt_pk_bf16_f32 v177, v178, v179
  v_cvt_pk_bf16_f32 v178, v180, v181
  v_cvt_pk_bf16_f32 v179, v182, v183
  buffer_store_dwordx4 v[176:179], v4, s[20:23], s64 offen offset:0 sc1
  s_waitcnt lgkmcnt(0)
  s_nop 0
  v_mfma_f32_16x16x32_bf16 v[176:179], v[188:191], v[160:163], 0
  v_mfma_f32_16x16x32_bf16 v[180:183], v[188:191], v[168:171], 0
  v_mfma_f32_16x16x32_bf16 v[176:179], v[12:15], v[164:167], v[176:179]
  v_mfma_f32_16x16x32_bf16 v[180:183], v[12:15], v[172:175], v[180:183]
  s_waitcnt vmcnt(8)
  v_mfma_f32_16x16x32_bf16 v[200:203], v[32:35], v[152:155], v[200:203]
  v_mfma_f32_16x16x32_bf16 v[216:219], v[36:39], v[152:155], v[216:219]
  v_mfma_f32_16x16x32_bf16 v[232:235], v[40:43], v[152:155], v[232:235]
  v_mfma_f32_16x16x32_bf16 v[248:251], v[44:47], v[152:155], v[248:251]
  buffer_load_dwordx4 v[152:155], v185, s[20:23], s60 offen offset:2048 sc1
  s_nop 0
  v_cvt_pk_bf16_f32 v176, v176, v177
  v_cvt_pk_bf16_f32 v177, v178, v179
  v_cvt_pk_bf16_f32 v178, v180, v181
  v_cvt_pk_bf16_f32 v179, v182, v183
  buffer_store_dwordx4 v[176:179], v4, s[20:23], s64 offen offset:1024 sc1
  s_waitcnt vmcnt(9)
  v_mfma_f32_16x16x32_bf16 v[204:207], v[32:35], v[156:159], v[204:207]
  v_mfma_f32_16x16x32_bf16 v[220:223], v[36:39], v[156:159], v[220:223]
  v_mfma_f32_16x16x32_bf16 v[236:239], v[40:43], v[156:159], v[236:239]
  v_mfma_f32_16x16x32_bf16 v[252:255], v[44:47], v[156:159], v[252:255]
  buffer_load_dwordx4 v[156:159], v185, s[20:23], s60 offen offset:3072 sc1
  s_waitcnt vmcnt(9)
  v_mfma_f32_16x16x32_bf16 v[192:195], v[48:51], v[128:131], v[192:195]
  v_mfma_f32_16x16x32_bf16 v[208:211], v[52:55], v[128:131], v[208:211]
  v_mfma_f32_16x16x32_bf16 v[224:227], v[56:59], v[128:131], v[224:227]
  v_mfma_f32_16x16x32_bf16 v[240:243], v[60:63], v[128:131], v[240:243]
  s_add_u32 s60, s85, 4
  s_sub_u32 s92, s60, 7
  s_cselect_b32 s60, s60, s92
  s_lshl_b32 s60, s60, 14
  buffer_load_dwordx4 v[128:131], v185, s[20:23], s60 offen offset:0 sc1
  s_waitcnt vmcnt(9)
  v_mfma_f32_16x16x32_bf16 v[196:199], v[48:51], v[132:135], v[196:199]
  v_mfma_f32_16x16x32_bf16 v[212:215], v[52:55], v[132:135], v[212:215]
  v_mfma_f32_16x16x32_bf16 v[228:231], v[56:59], v[132:135], v[228:231]
  v_mfma_f32_16x16x32_bf16 v[244:247], v[60:63], v[132:135], v[244:247]
  buffer_load_dwordx4 v[132:135], v185, s[20:23], s60 offen offset:1024 sc1
  s_waitcnt vmcnt(9)
  v_mfma_f32_16x16x32_bf16 v[200:203], v[48:51], v[136:139], v[200:203]
  v_mfma_f32_16x16x32_bf16 v[216:219], v[52:55], v[136:139], v[216:219]
  v_mfma_f32_16x16x32_bf16 v[232:235], v[56:59], v[136:139], v[232:235]
  v_mfma_f32_16x16x32_bf16 v[248:251], v[60:63], v[136:139], v[248:251]
  buffer_load_dwordx4 v[136:139], v185, s[20:23], s60 offen offset:2048 sc1
  s_waitcnt vmcnt(9)
  v_mfma_f32_16x16x32_bf16 v[204:207], v[48:51], v[140:143], v[204:207]
  v_mfma_f32_16x16x32_bf16 v[220:223], v[52:55], v[140:143], v[220:223]
  v_mfma_f32_16x16x32_bf16 v[236:239], v[56:59], v[140:143], v[236:239]
  v_mfma_f32_16x16x32_bf16 v[252:255], v[60:63], v[140:143], v[252:255]
  buffer_load_dwordx4 v[140:143], v185, s[20:23], s60 offen offset:3072 sc1
  s_waitcnt vmcnt(9)
  v_mfma_f32_16x16x32_bf16 v[192:195], v[64:67], v[144:147], v[192:195]
  v_mfma_f32_16x16x32_bf16 v[208:211], v[68:71], v[144:147], v[208:211]
  v_mfma_f32_16x16x32_bf16 v[224:227], v[72:75], v[144:147], v[224:227]
  v_mfma_f32_16x16x32_bf16 v[240:243], v[76:79], v[144:147], v[240:243]
  s_add_u32 s60, s85, 5
  s_sub_u32 s92, s60, 7
  s_cselect_b32 s60, s60, s92
  s_lshl_b32 s60, s60, 14
  buffer_load_dwordx4 v[144:147], v185, s[20:23], s60 offen offset:0 sc1
  s_waitcnt vmcnt(9)
  v_mfma_f32_16x16x32_bf16 v[196:199], v[64:67], v[148:151], v[196:199]
  v_mfma_f32_16x16x32_bf16 v[212:215], v[68:71], v[148:151], v[212:215]
  v_mfma_f32_16x16x32_bf16 v[228:231], v[72:75], v[148:151], v[228:231]
  v_mfma_f32_16x16x32_bf16 v[244:247], v[76:79], v[148:151], v[244:247]
  buffer_load_dwordx4 v[148:151], v185, s[20:23], s60 offen offset:1024 sc1
  s_waitcnt vmcnt(8)
  v_mfma_f32_16x16x32_bf16 v[200:203], v[64:67], v[152:155], v[200:203]
  v_mfma_f32_16x16x32_bf16 v[216:219], v[68:71], v[152:155], v[216:219]
  v_mfma_f32_16x16x32_bf16 v[232:235], v[72:75], v[152:155], v[232:235]
  v_mfma_f32_16x16x32_bf16 v[248:251], v[76:79], v[152:155], v[248:251]
  buffer_load_dwordx4 v[152:155], v185, s[20:23], s60 offen offset:2048 sc1
  s_waitcnt vmcnt(8)
  s_atomic_add s81, s[6:7], s65
  s_xor_b32 s64, s64, 8192
  s_xor_b32 s65, s65, 256
  v_xor_b32 v177, 32, v10
  v_xor_b32 v178, 64, v10
  v_xor_b32 v179, 96, v10
  s_lshl_b32 s56, s48, 10
  s_add_u32 s56, s56, 98304
  v_lshl_add_u32 v176, v0, 4, s56
  s_waitcnt vmcnt(7)
  v_mfma_f32_16x16x32_bf16 v[204:207], v[64:67], v[156:159], v[204:207]
  v_mfma_f32_16x16x32_bf16 v[220:223], v[68:71], v[156:159], v[220:223]
  v_mfma_f32_16x16x32_bf16 v[236:239], v[72:75], v[156:159], v[236:239]
  v_mfma_f32_16x16x32_bf16 v[252:255], v[76:79], v[156:159], v[252:255]
  buffer_load_dwordx4 v[156:159], v185, s[20:23], s60 offen offset:3072 sc1
  s_waitcnt vmcnt(7)
  v_mfma_f32_16x16x32_bf16 v[192:195], v[80:83], v[128:131], v[192:195]
  v_mfma_f32_16x16x32_bf16 v[208:211], v[84:87], v[128:131], v[208:211]
  v_mfma_f32_16x16x32_bf16 v[224:227], v[88:91], v[128:131], v[224:227]
  v_mfma_f32_16x16x32_bf16 v[240:243], v[92:95], v[128:131], v[240:243]
  s_add_u32 s60, s85, 6
  s_sub_u32 s92, s60, 7
  s_cselect_b32 s60, s60, s92
  s_lshl_b32 s60, s60, 14
  buffer_load_dwordx4 v[128:131], v185, s[20:23], s60 offen offset:0 sc1
  s_waitcnt vmcnt(7)
  v_mfma_f32_16x16x32_bf16 v[196:199], v[80:83], v[132:135], v[196:199]
  v_mfma_f32_16x16x32_bf16 v[212:215], v[84:87], v[132:135], v[212:215]
  v_mfma_f32_16x16x32_bf16 v[228:231], v[88:91], v[132:135], v[228:231]
  v_mfma_f32_16x16x32_bf16 v[244:247], v[92:95], v[132:135], v[244:247]
  buffer_load_dwordx4 v[132:135], v185, s[20:23], s60 offen offset:1024 sc1
  s_waitcnt vmcnt(7)
  v_mfma_f32_16x16x32_bf16 v[200:203], v[80:83], v[136:139], v[200:203]
  v_mfma_f32_16x16x32_bf16 v[216:219], v[84:87], v[136:139], v[216:219]
  v_mfma_f32_16x16x32_bf16 v[232:235], v[88:91], v[136:139], v[232:235]
  v_mfma_f32_16x16x32_bf16 v[248:251], v[92:95], v[136:139], v[248:251]
  buffer_load_dwordx4 v[136:139], v185, s[20:23], s60 offen offset:2048 sc1
  s_waitcnt vmcnt(7)
  v_mfma_f32_16x16x32_bf16 v[204:207], v[80:83], v[140:143], v[204:207]
  v_mfma_f32_16x16x32_bf16 v[220:223], v[84:87], v[140:143], v[220:223]
  v_mfma_f32_16x16x32_bf16 v[236:239], v[88:91], v[140:143], v[236:239]
  v_mfma_f32_16x16x32_bf16 v[252:255], v[92:95], v[140:143], v[252:255]
  buffer_load_dwordx4 v[140:143], v185, s[20:23], s60 offen offset:3072 sc1
  s_mov_b32 s95, 0
  s_atomic_add s95, s[6:7], s65 glc
  s_waitcnt vmcnt(7)
  v_mfma_f32_16x16x32_bf16 v[192:195], v[96:99], v[144:147], v[192:195]
  v_mfma_f32_16x16x32_bf16 v[208:211], v[100:103], v[144:147], v[208:211]
  v_mfma_f32_16x16x32_bf16 v[224:227], v[104:107], v[144:147], v[224:227]
  v_mfma_f32_16x16x32_bf16 v[240:243], v[108:111], v[144:147], v[240:243]
  s_waitcnt vmcnt(6)
  v_mfma_f32_16x16x32_bf16 v[196:199], v[96:99], v[148:151], v[196:199]
  v_mfma_f32_16x16x32_bf16 v[212:215], v[100:103], v[148:151], v[212:215]
  v_mfma_f32_16x16x32_bf16 v[228:231], v[104:107], v[148:151], v[228:231]
  v_mfma_f32_16x16x32_bf16 v[244:247], v[108:111], v[148:151], v[244:247]
  s_waitcnt vmcnt(5)
  v_mfma_f32_16x16x32_bf16 v[200:203], v[96:99], v[152:155], v[200:203]
  v_mfma_f32_16x16x32_bf16 v[216:219], v[100:103], v[152:155], v[216:219]
  v_mfma_f32_16x16x32_bf16 v[232:235], v[104:107], v[152:155], v[232:235]
  v_mfma_f32_16x16x32_bf16 v[248:251], v[108:111], v[152:155], v[248:251]
  s_waitcnt vmcnt(4)
  v_mfma_f32_16x16x32_bf16 v[204:207], v[96:99], v[156:159], v[204:207]
  v_mfma_f32_16x16x32_bf16 v[220:223], v[100:103], v[156:159], v[220:223]
  v_mfma_f32_16x16x32_bf16 v[236:239], v[104:107], v[156:159], v[236:239]
  v_mfma_f32_16x16x32_bf16 v[252:255], v[108:111], v[156:159], v[252:255]
  s_waitcnt lgkmcnt(0)
  s_cmp_ge_u32 s95, 4
  s_cbranch_scc1 SX20
  s_mov_b32 s63, 0x80000
SP20:
  s_mov_b32 s62, 0
  s_atomic_add s62, s[6:7], s65 glc
  s_waitcnt lgkmcnt(0)
  s_cmp_ge_u32 s62, 4
  s_cbranch_scc1 SX20
  s_sub_u32 s63, s63, 1
  s_cbranch_scc1 SX20
  s_sleep 5
  s_branch SP20
SX20:
  s_lshl_b32 s55, s49, 11
  s_add_u32 m0, s55, 98304
  s_nop 0
  buffer_load_dwordx4 v4, s[20:23], s64 offen offset:0 sc1 lds
  buffer_load_dwordx4 v4, s[20:23], s64 offen offset:1024 sc1 lds
  s_waitcnt vmcnt(5)
  v_mfma_f32_16x16x32_bf16 v[192:195], v[112:115], v[128:131], v[192:195]
  v_mfma_f32_16x16x32_bf16 v[208:211], v[116:119], v[128:131], v[208:211]
  v_mfma_f32_16x16x32_bf16 v[224:227], v[120:123], v[128:131], v[224:227]
  v_mfma_f32_16x16x32_bf16 v[240:243], v[124:127], v[128:131], v[240:243]
  s_waitcnt vmcnt(4)
  v_mfma_f32_16x16x32_bf16 v[196:199], v[112:115], v[132:135], v[196:199]
  v_mfma_f32_16x16x32_bf16 v[212:215], v[116:119], v[132:135], v[212:215]
  s_nop 1
  v_cvt_pk_bf16_f32 v192, v192, v193
  v_cvt_pk_bf16_f32 v193, v194, v195
  ds_write_b64 v6, v[192:193] offset:0
  v_cvt_pk_bf16_f32 v208, v208, v209
  v_mfma_f32_16x16x32_bf16 v[228:231], v[120:123], v[132:135], v[228:231]
  v_cvt_pk_bf16_f32 v209, v210, v211
  ds_write_b64 v7, v[208:209] offset:0
  v_cvt_pk_bf16_f32 v224, v224, v225
  v_cvt_pk_bf16_f32 v225, v226, v227
  v_mfma_f32_16x16x32_bf16 v[244:247], v[124:127], v[132:135], v[244:247]
  ds_write_b64 v8, v[224:225] offset:0
  v_cvt_pk_bf16_f32 v240, v240, v241
  v_cvt_pk_bf16_f32 v241, v242, v243
  ds_write_b64 v9, v[240:241] offset:0
  s_waitcnt vmcnt(3)
  v_mfma_f32_16x16x32_bf16 v[200:203], v[112:115], v[136:139], v[200:203]
  v_mfma_f32_16x16x32_bf16 v[216:219], v[116:119], v[136:139], v[216:219]
  v_cvt_pk_bf16_f32 v196, v196, v197
  v_cvt_pk_bf16_f32 v197, v198, v199
  ds_write_b64 v6, v[196:197] offset:2048
  v_cvt_pk_bf16_f32 v212, v212, v213
  v_mfma_f32_16x16x32_bf16 v[232:235], v[120:123], v[136:139], v[232:235]
  v_cvt_pk_bf16_f32 v213, v214, v215
  ds_write_b64 v7, v[212:213] offset:2048
  v_cvt_pk_bf16_f32 v228, v228, v229
  v_cvt_pk_bf16_f32 v229, v230, v231
  v_mfma_f32_16x16x32_bf16 v[248:251], v[124:127], v[136:139], v[248:251]
  ds_write_b64 v8, v[228:229] offset:2048
  v_cvt_pk_bf16_f32 v244, v244, v245
  v_cvt_pk_bf16_f32 v245, v246, v247
  ds_write_b64 v9, v[244:245] offset:2048
  s_waitcnt vmcnt(2)
  v_mfma_f32_16x16x32_bf16 v[204:207], v[112:115], v[140:143], v[204:207]
  v_mfma_f32_16x16x32_bf16 v[220:223], v[116:119], v[140:143], v[220:223]
  v_cvt_pk_bf16_f32 v200, v200, v201
  v_cvt_pk_bf16_f32 v201, v202, v203
  ds_write_b64 v6, v[200:201] offset:4096
  v_cvt_pk_bf16_f32 v216, v216, v217
  v_mfma_f32_16x16x32_bf16 v[236:239], v[120:123], v[140:143], v[236:239]
  v_cvt_pk_bf16_f32 v217, v218, v219
  ds_write_b64 v7, v[216:217] offset:4096
  v_cvt_pk_bf16_f32 v232, v232, v233
  v_cvt_pk_bf16_f32 v233, v234, v235
  v_mfma_f32_16x16x32_bf16 v[252:255], v[124:127], v[140:143], v[252:255]
  ds_write_b64 v8, v[232:233] offset:4096
  v_cvt_pk_bf16_f32 v248, v248, v249
  v_cvt_pk_bf16_f32 v249, v250, v251
  ds_write_b64 v9, v[248:249] offset:4096
  s_branch L_part
  .p2align 12, 0
  .space 0
L_dftm:
  s_load_dwordx2 s[24:25], s[0:1], 48
  s_mov_b32 s26, 1835008
  s_mov_b32 s27, 0x20000
  s_load_dwordx2 s[28:29], s[0:1], 64
  s_mov_b32 s30, 2097152
  s_mov_b32 s31, 0x20000
  s_load_dwordx2 s[32:33], s[0:1], 72
  s_mov_b32 s34, 256
  s_mov_b32 s35, 0x20000
  s_load_dwordx2 s[36:37], s[0:1], 8
  s_mov_b32 s38, 1052672
  s_mov_b32 s39, 0x20000
  s_load_dwordx2 s[40:41], s[0:1], 16
  s_mov_b32 s42, 1052672
  s_mov_b32 s43, 0x20000
  v_and_b32 v1, 15, v0
  v_lshlrev_b32 v1, 2, v1
  v_add_u32 v1, 156160, v1
  v_mov_b32 v2, 0
  ds_write_b32 v1, v2
  v_and_b32 v14, 15, v0
  v_lshrrev_b32 v15, 5, v0
  v_bfe_u32 v13, v0, 4, 1
  v_and_b32 v2, 31, v0
  s_lshl_b32 s55, s49, 6
  s_add_u32 s55, s55, s52
  v_lshl_add_u32 v164, v2, 1, s55
  v_cvt_f32_u32 v1, v164
  v_mul_f32 v160, 0x3b000000, v1
  v_lshlrev_b32 v1, 3, v15
  v_cvt_f32_u32 v1, v1
  v_mul_f32 v162, v1, v160
  v_lshlrev_b32 v4, 9, v2
  v_xor_b32 v1, v14, v15
  v_lshl_add_u32 v4, v1, 4, v4
  v_lshl_add_u32 v1, v15, 2, v13
  v_mul_u32_u24 v1, 16896, v1
  v_lshl_add_u32 v12, v14, 4, v1
  v_xor_b32 v5, 32, v4
  v_xor_b32 v6, 64, v4
  v_xor_b32 v7, 96, v4
  v_xor_b32 v8, 128, v4
  v_xor_b32 v9, 160, v4
  v_xor_b32 v10, 192, v4
  v_xor_b32 v11, 224, v4
  s_sub_u32 s55, s2, 225
  s_lshl_b32 s80, s49, 8
  s_add_u32 s80, s80, s55
  s_cmp_ge_u32 s80, 7
  s_cbranch_scc1 L_nozero
  v_lshlrev_b32 v1, 8, v0
  v_mov_b32 v2, 0
  s_lshl_b32 s55, s55, 14
  s_add_u32 s55, s55, 17891328
  s_waitcnt lgkmcnt(0)
  buffer_store_dword v2, v1, s[20:23], s55 offen sc1
L_nozero:
  v_fmamk_f32 v192, v160, 0x00000000, v162
  v_fmamk_f32 v193, v160, 0x3f800000, v162
  v_cos_f32 v194, v192
  v_cos_f32 v195, v193
  v_sin_f32 v196, v192
  v_sin_f32 v197, v193
  v_cvt_pk_bf16_f32 v16, v194, v195
  v_cvt_pk_bf16_f32 v20, -v196, -v197
  v_fmamk_f32 v192, v160, 0x40000000, v162
  v_fmamk_f32 v193, v160, 0x40400000, v162
  v_cos_f32 v194, v192
  v_cos_f32 v195, v193
  v_sin_f32 v196, v192
  v_sin_f32 v197, v193
  v_cvt_pk_bf16_f32 v17, v194, v195
  v_cvt_pk_bf16_f32 v21, -v196, -v197
  v_fmamk_f32 v192, v160, 0x40800000, v162
  v_fmamk_f32 v193, v160, 0x40a00000, v162
  v_cos_f32 v194, v192
  v_cos_f32 v195, v193
  v_sin_f32 v196, v192
  v_sin_f32 v197, v193
  v_cvt_pk_bf16_f32 v18, v194, v195
  v_cvt_pk_bf16_f32 v22, -v196, -v197
  v_fmamk_f32 v192, v160, 0x40c00000, v162
  v_fmamk_f32 v193, v160, 0x40e00000, v162
  v_cos_f32 v194, v192
  v_cos_f32 v195, v193
  v_sin_f32 v196, v192
  v_sin_f32 v197, v193
  v_cvt_pk_bf16_f32 v19, v194, v195
  v_cvt_pk_bf16_f32 v23, -v196, -v197
  v_fmamk_f32 v192, v160, 0x41800000, v162
  v_fmamk_f32 v193, v160, 0x41880000, v162
  v_cos_f32 v194, v192
  v_cos_f32 v195, v193
  v_sin_f32 v196, v192
  v_sin_f32 v197, v193
  v_cvt_pk_bf16_f32 v24, v194, v195
  v_cvt_pk_bf16_f32 v28, -v196, -v197
  v_fmamk_f32 v192, v160, 0x41900000, v162
  v_fmamk_f32 v193, v160, 0x41980000, v162
  v_cos_f32 v194, v192
  v_cos_f32 v195, v193
  v_sin_f32 v196, v192
  v_sin_f32 v197, v193
  v_cvt_pk_bf16_f32 v25, v194, v195
  v_cvt_pk_bf16_f32 v29, -v196, -v197
  v_fmamk_f32 v192, v160, 0x41a00000, v162
  v_fmamk_f32 v193, v160, 0x41a80000, v162
  v_cos_f32 v194, v192
  v_cos_f32 v195, v193
  v_sin_f32 v196, v192
  v_sin_f32 v197, v193
  v_cvt_pk_bf16_f32 v26, v194, v195
  v_cvt_pk_bf16_f32 v30, -v196, -v197
  v_fmamk_f32 v192, v160, 0x41b00000, v162
  v_fmamk_f32 v193, v160, 0x41b80000, v162
  v_cos_f32 v194, v192
  v_cos_f32 v195, v193
  v_sin_f32 v196, v192
  v_sin_f32 v197, v193
  v_cvt_pk_bf16_f32 v27, v194, v195
  v_cvt_pk_bf16_f32 v31, -v196, -v197
  v_fmamk_f32 v192, v160, 0x42000000, v162
  v_fmamk_f32 v193, v160, 0x42040000, v162
  v_cos_f32 v194, v192
  v_cos_f32 v195, v193
  v_sin_f32 v196, v192
  v_sin_f32 v197, v193
  v_cvt_pk_bf16_f32 v32, v194, v195
  v_cvt_pk_bf16_f32 v36, -v196, -v197
  v_fmamk_f32 v192, v160, 0x42080000, v162
  v_fmamk_f32 v193, v160, 0x420c0000, v162
  v_cos_f32 v194, v192
  v_cos_f32 v195, v193
  v_sin_f32 v196, v192
  v_sin_f32 v197, v193
  v_cvt_pk_bf16_f32 v33, v194, v195
  v_cvt_pk_bf16_f32 v37, -v196, -v197
  v_fmamk_f32 v192, v160, 0x42100000, v162
  v_fmamk_f32 v193, v160, 0x42140000, v162
  v_cos_f32 v194, v192
  v_cos_f32 v195, v193
  v_sin_f32 v196, v192
  v_sin_f32 v197, v193
  v_cvt_pk_bf16_f32 v34, v194, v195
  v_cvt_pk_bf16_f32 v38, -v196, -v197
  v_fmamk_f32 v192, v160, 0x42180000, v162
  v_fmamk_f32 v193, v160, 0x421c0000, v162
  v_cos_f32 v194, v192
  v_cos_f32 v195, v193
  v_sin_f32 v196, v192
  v_sin_f32 v197, v193
  v_cvt_pk_bf16_f32 v35, v194, v195
  v_cvt_pk_bf16_f32 v39, -v196, -v197
  v_fmamk_f32 v192, v160, 0x42400000, v162
  v_fmamk_f32 v193, v160, 0x42440000, v162
  v_cos_f32 v194, v192
  v_cos_f32 v195, v193
  v_sin_f32 v196, v192
  v_sin_f32 v197, v193
  v_cvt_pk_bf16_f32 v40, v194, v195
  v_cvt_pk_bf16_f32 v44, -v196, -v197
  v_fmamk_f32 v192, v160, 0x42480000, v162
  v_fmamk_f32 v193, v160, 0x424c0000, v162
  v_cos_f32 v194, v192
  v_cos_f32 v195, v193
  v_sin_f32 v196, v192
  v_sin_f32 v197, v193
  v_cvt_pk_bf16_f32 v41, v194, v195
  v_cvt_pk_bf16_f32 v45, -v196, -v197
  v_fmamk_f32 v192, v160, 0x42500000, v162
  v_fmamk_f32 v193, v160, 0x42540000, v162
  v_cos_f32 v194, v192
  v_cos_f32 v195, v193
  v_sin_f32 v196, v192
  v_sin_f32 v197, v193
  v_cvt_pk_bf16_f32 v42, v194, v195
  v_cvt_pk_bf16_f32 v46, -v196, -v197
  v_fmamk_f32 v192, v160, 0x42580000, v162
  v_fmamk_f32 v193, v160, 0x425c0000, v162
  v_cos_f32 v194, v192
  v_cos_f32 v195, v193
  v_sin_f32 v196, v192
  v_sin_f32 v197, v193
  v_cvt_pk_bf16_f32 v43, v194, v195
  v_cvt_pk_bf16_f32 v47, -v196, -v197
  v_fmamk_f32 v192, v160, 0x42800000, v162
  v_fmamk_f32 v193, v160, 0x42820000, v162
  v_cos_f32 v194, v192
  v_cos_f32 v195, v193
  v_sin_f32 v196, v192
  v_sin_f32 v197, v193
  v_cvt_pk_bf16_f32 v48, v194, v195
  v_cvt_pk_bf16_f32 v52, -v196, -v197
  v_fmamk_f32 v192, v160, 0x42840000, v162
  v_fmamk_f32 v193, v160, 0x42860000, v162
  v_cos_f32 v194, v192
  v_cos_f32 v195, v193
  v_sin_f32 v196, v192
  v_sin_f32 v197, v193
  v_cvt_pk_bf16_f32 v49, v194, v195
  v_cvt_pk_bf16_f32 v53, -v196, -v197
  v_fmamk_f32 v192, v160, 0x42880000, v162
  v_fmamk_f32 v193, v160, 0x428a0000, v162
  v_cos_f32 v194, v192
  v_cos_f32 v195, v193
  v_sin_f32 v196, v192
  v_sin_f32 v197, v193
  v_cvt_pk_bf16_f32 v50, v194, v195
  v_cvt_pk_bf16_f32 v54, -v196, -v197
  v_fmamk_f32 v192, v160, 0x428c0000, v162
  v_fmamk_f32 v193, v160, 0x428e0000, v162
  v_cos_f32 v194, v192
  v_cos_f32 v195, v193
  v_sin_f32 v196, v192
  v_sin_f32 v197, v193
  v_cvt_pk_bf16_f32 v51, v194, v195
  v_cvt_pk_bf16_f32 v55, -v196, -v197
  v_fmamk_f32 v192, v160, 0x42a00000, v162
  v_fmamk_f32 v193, v160, 0x42a20000, v162
  v_cos_f32 v194, v192
  v_cos_f32 v195, v193
  v_sin_f32 v196, v192
  v_sin_f32 v197, v193
  v_cvt_pk_bf16_f32 v56, v194, v195
  v_cvt_pk_bf16_f32 v60, -v196, -v197
  v_fmamk_f32 v192, v160, 0x42a40000, v162
  v_fmamk_f32 v193, v160, 0x42a60000, v162
  v_cos_f32 v194, v192
  v_cos_f32 v195, v193
  v_sin_f32 v196, v192
  v_sin_f32 v197, v193
  v_cvt_pk_bf16_f32 v57, v194, v195
  v_cvt_pk_bf16_f32 v61, -v196, -v197
  v_fmamk_f32 v192, v160, 0x42a80000, v162
  v_fmamk_f32 v193, v160, 0x42aa0000, v162
  v_cos_f32 v194, v192
  v_cos_f32 v195, v193
  v_sin_f32 v196, v192
  v_sin_f32 v197, v193
  v_cvt_pk_bf16_f32 v58, v194, v195
  v_cvt_pk_bf16_f32 v62, -v196, -v197
  v_fmamk_f32 v192, v160, 0x42ac0000, v162
  v_fmamk_f32 v193, v160, 0x42ae0000, v162
  v_cos_f32 v194, v192
  v_cos_f32 v195, v193
  v_sin_f32 v196, v192
  v_sin_f32 v197, v193
  v_cvt_pk_bf16_f32 v59, v194, v195
  v_cvt_pk_bf16_f32 v63, -v196, -v197
  v_fmamk_f32 v192, v160, 0x42c00000, v162
  v_fmamk_f32 v193, v160, 0x42c20000, v162
  v_cos_f32 v194, v192
  v_cos_f32 v195, v193
  v_sin_f32 v196, v192
  v_sin_f32 v197, v193
  v_cvt_pk_bf16_f32 v64, v194, v195
  v_cvt_pk_bf16_f32 v68, -v196, -v197
  v_fmamk_f32 v192, v160, 0x42c40000, v162
  v_fmamk_f32 v193, v160, 0x42c60000, v162
  v_cos_f32 v194, v192
  v_cos_f32 v195, v193
  v_sin_f32 v196, v192
  v_sin_f32 v197, v193
  v_cvt_pk_bf16_f32 v65, v194, v195
  v_cvt_pk_bf16_f32 v69, -v196, -v197
  v_fmamk_f32 v192, v160, 0x42c80000, v162
  v_fmamk_f32 v193, v160, 0x42ca0000, v162
  v_cos_f32 v194, v192
  v_cos_f32 v195, v193
  v_sin_f32 v196, v192
  v_sin_f32 v197, v193
  v_cvt_pk_bf16_f32 v66, v194, v195
  v_cvt_pk_bf16_f32 v70, -v196, -v197
  v_fmamk_f32 v192, v160, 0x42cc0000, v162
  v_fmamk_f32 v193, v160, 0x42ce0000, v162
  v_cos_f32 v194, v192
  v_cos_f32 v195, v193
  v_sin_f32 v196, v192
  v_sin_f32 v197, v193
  v_cvt_pk_bf16_f32 v67, v194, v195
  v_cvt_pk_bf16_f32 v71, -v196, -v197
  v_fmamk_f32 v192, v160, 0x42e00000, v162
  v_fmamk_f32 v193, v160, 0x42e20000, v162
  v_cos_f32 v194, v192
  v_cos_f32 v195, v193
  v_sin_f32 v196, v192
  v_sin_f32 v197, v193
  v_cvt_pk_bf16_f32 v72, v194, v195
  v_cvt_pk_bf16_f32 v76, -v196, -v197
  v_fmamk_f32 v192, v160, 0x42e40000, v162
  v_fmamk_f32 v193, v160, 0x42e60000, v162
  v_cos_f32 v194, v192
  v_cos_f32 v195, v193
  v_sin_f32 v196, v192
  v_sin_f32 v197, v193
  v_cvt_pk_bf16_f32 v73, v194, v195
  v_cvt_pk_bf16_f32 v77, -v196, -v197
  v_fmamk_f32 v192, v160, 0x42e80000, v162
  v_fmamk_f32 v193, v160, 0x42ea0000, v162
  v_cos_f32 v194, v192
  v_cos_f32 v195, v193
  v_sin_f32 v196, v192
  v_sin_f32 v197, v193
  v_cvt_pk_bf16_f32 v74, v194, v195
  v_cvt_pk_bf16_f32 v78, -v196, -v197
  v_fmamk_f32 v192, v160, 0x42ec0000, v162
  v_fmamk_f32 v193, v160, 0x42ee0000, v162
  v_cos_f32 v194, v192
  v_cos_f32 v195, v193
  v_sin_f32 v196, v192
  v_sin_f32 v197, v193
  v_cvt_pk_bf16_f32 v75, v194, v195
  v_cvt_pk_bf16_f32 v79, -v196, -v197
  v_bfe_u32 v1, v164, 1, 1
  v_mul_u32_u24 v1, 0x8000, v1
  v_lshl_or_b32 v1, v1, 16, v1
  s_cmp_eq_u32 s52, 1
  s_cbranch_scc1 L_odd
  v_cmp_eq_u32 vcc, 0, v164
  v_mov_b32 v2, 0xbf803f80
  s_cbranch_vccz L_nok0
  v_cndmask_b32 v20, v20, v2, vcc
  v_cndmask_b32 v21, v21, v2, vcc
  v_cndmask_b32 v22, v22, v2, vcc
  v_cndmask_b32 v23, v23, v2, vcc
  v_cndmask_b32 v28, v28, v2, vcc
  v_cndmask_b32 v29, v29, v2, vcc
  v_cndmask_b32 v30, v30, v2, vcc
  v_cndmask_b32 v31, v31, v2, vcc
  v_cndmask_b32 v36, v36, v2, vcc
  v_cndmask_b32 v37, v37, v2, vcc
  v_cndmask_b32 v38, v38, v2, vcc
  v_cndmask_b32 v39, v39, v2, vcc
  v_cndmask_b32 v44, v44, v2, vcc
  v_cndmask_b32 v45, v45, v2, vcc
  v_cndmask_b32 v46, v46, v2, vcc
  v_cndmask_b32 v47, v47, v2, vcc
  v_cndmask_b32 v52, v52, v2, vcc
  v_cndmask_b32 v53, v53, v2, vcc
  v_cndmask_b32 v54, v54, v2, vcc
  v_cndmask_b32 v55, v55, v2, vcc
  v_cndmask_b32 v60, v60, v2, vcc
  v_cndmask_b32 v61, v61, v2, vcc
  v_cndmask_b32 v62, v62, v2, vcc
  v_cndmask_b32 v63, v63, v2, vcc
  v_cndmask_b32 v68, v68, v2, vcc
  v_cndmask_b32 v69, v69, v2, vcc
  v_cndmask_b32 v70, v70, v2, vcc
  v_cndmask_b32 v71, v71, v2, vcc
  v_cndmask_b32 v76, v76, v2, vcc
  v_cndmask_b32 v77, v77, v2, vcc
  v_cndmask_b32 v78, v78, v2, vcc
  v_cndmask_b32 v79, v79, v2, vcc
L_nok0:
  v_xor_b32 v80, v1, v16
  v_xor_b32 v81, v1, v17
  v_xor_b32 v82, v1, v18
  v_xor_b32 v83, v1, v19
  v_xor_b32 v84, v1, v20
  v_xor_b32 v85, v1, v21
  v_xor_b32 v86, v1, v22
  v_xor_b32 v87, v1, v23
  v_xor_b32 v88, v1, v24
  v_xor_b32 v89, v1, v25
  v_xor_b32 v90, v1, v26
  v_xor_b32 v91, v1, v27
  v_xor_b32 v92, v1, v28
  v_xor_b32 v93, v1, v29
  v_xor_b32 v94, v1, v30
  v_xor_b32 v95, v1, v31
  v_xor_b32 v96, v1, v32
  v_xor_b32 v97, v1, v33
  v_xor_b32 v98, v1, v34
  v_xor_b32 v99, v1, v35
  v_xor_b32 v100, v1, v36
  v_xor_b32 v101, v1, v37
  v_xor_b32 v102, v1, v38
  v_xor_b32 v103, v1, v39
  v_xor_b32 v104, v1, v40
  v_xor_b32 v105, v1, v41
  v_xor_b32 v106, v1, v42
  v_xor_b32 v107, v1, v43
  v_xor_b32 v108, v1, v44
  v_xor_b32 v109, v1, v45
  v_xor_b32 v110, v1, v46
  v_xor_b32 v111, v1, v47
  v_xor_b32 v112, v1, v48
  v_xor_b32 v113, v1, v49
  v_xor_b32 v114, v1, v50
  v_xor_b32 v115, v1, v51
  v_xor_b32 v116, v1, v52
  v_xor_b32 v117, v1, v53
  v_xor_b32 v118, v1, v54
  v_xor_b32 v119, v1, v55
  v_xor_b32 v120, v1, v56
  v_xor_b32 v121, v1, v57
  v_xor_b32 v122, v1, v58
  v_xor_b32 v123, v1, v59
  v_xor_b32 v124, v1, v60
  v_xor_b32 v125, v1, v61
  v_xor_b32 v126, v1, v62
  v_xor_b32 v127, v1, v63
  v_xor_b32 v128, v1, v64
  v_xor_b32 v129, v1, v65
  v_xor_b32 v130, v1, v66
  v_xor_b32 v131, v1, v67
  v_xor_b32 v132, v1, v68
  v_xor_b32 v133, v1, v69
  v_xor_b32 v134, v1, v70
  v_xor_b32 v135, v1, v71
  v_xor_b32 v136, v1, v72
  v_xor_b32 v137, v1, v73
  v_xor_b32 v138, v1, v74
  v_xor_b32 v139, v1, v75
  v_xor_b32 v140, v1, v76
  v_xor_b32 v141, v1, v77
  v_xor_b32 v142, v1, v78
  v_xor_b32 v143, v1, v79
  s_branch L_fdone
L_odd:
  v_xor_b32 v2, 0x80008000, v1
  v_xor_b32 v80, v1, v20
  v_xor_b32 v81, v1, v21
  v_xor_b32 v82, v1, v22
  v_xor_b32 v83, v1, v23
  v_xor_b32 v84, v2, v16
  v_xor_b32 v85, v2, v17
  v_xor_b32 v86, v2, v18
  v_xor_b32 v87, v2, v19
  v_xor_b32 v88, v1, v28
  v_xor_b32 v89, v1, v29
  v_xor_b32 v90, v1, v30
  v_xor_b32 v91, v1, v31
  v_xor_b32 v92, v2, v24
  v_xor_b32 v93, v2, v25
  v_xor_b32 v94, v2, v26
  v_xor_b32 v95, v2, v27
  v_xor_b32 v96, v1, v36
  v_xor_b32 v97, v1, v37
  v_xor_b32 v98, v1, v38
  v_xor_b32 v99, v1, v39
  v_xor_b32 v100, v2, v32
  v_xor_b32 v101, v2, v33
  v_xor_b32 v102, v2, v34
  v_xor_b32 v103, v2, v35
  v_xor_b32 v104, v1, v44
  v_xor_b32 v105, v1, v45
  v_xor_b32 v106, v1, v46
  v_xor_b32 v107, v1, v47
  v_xor_b32 v108, v2, v40
  v_xor_b32 v109, v2, v41
  v_xor_b32 v110, v2, v42
  v_xor_b32 v111, v2, v43
  v_xor_b32 v112, v1, v52
  v_xor_b32 v113, v1, v53
  v_xor_b32 v114, v1, v54
  v_xor_b32 v115, v1, v55
  v_xor_b32 v116, v2, v48
  v_xor_b32 v117, v2, v49
  v_xor_b32 v118, v2, v50
  v_xor_b32 v119, v2, v51
  v_xor_b32 v120, v1, v60
  v_xor_b32 v121, v1, v61
  v_xor_b32 v122, v1, v62
  v_xor_b32 v123, v1, v63
  v_xor_b32 v124, v2, v56
  v_xor_b32 v125, v2, v57
  v_xor_b32 v126, v2, v58
  v_xor_b32 v127, v2, v59
  v_xor_b32 v128, v1, v68
  v_xor_b32 v129, v1, v69
  v_xor_b32 v130, v1, v70
  v_xor_b32 v131, v1, v71
  v_xor_b32 v132, v2, v64
  v_xor_b32 v133, v2, v65
  v_xor_b32 v134, v2, v66
  v_xor_b32 v135, v2, v67
  v_xor_b32 v136, v1, v76
  v_xor_b32 v137, v1, v77
  v_xor_b32 v138, v1, v78
  v_xor_b32 v139, v1, v79
  v_xor_b32 v140, v2, v72
  v_xor_b32 v141, v2, v73
  v_xor_b32 v142, v2, v74
  v_xor_b32 v143, v2, v75
L_fdone:
  s_lshl_b32 s55, s49, 6
  s_add_u32 s55, s55, s52
  s_mul_i32 s55, s55, 8448
  s_lshl_b32 s56, s50, 9
  s_add_u32 s55, s55, s56
  s_add_u32 s57, s55, 8388608
  s_lshl_b32 s56, s52, 8
  s_sub_u32 s58, s57, s56
  s_add_u32 s57, s57, s56
  s_waitcnt lgkmcnt(0)
  s_add_u32 s6, s20, 17891328
  s_addc_u32 s7, s21, 0
  s_mov_b32 s81, 1
  s_mov_b32 s82, 156160
  s_mov_b32 s83, 147456
  s_waitcnt vmcnt(0)
  s_cmp_ge_u32 s80, 7
  s_cbranch_scc1 L_noini
  s_mov_b32 s81, 1
  s_waitcnt lgkmcnt(0)
  s_atomic_add s81, s[32:33], 0x0
L_noini:
  s_barrier
  ds_read_b128 v[144:147], v4 offset:0
  ds_read_b128 v[148:151], v5 offset:0
  ds_read_b128 v[152:155], v6 offset:0
  s_waitcnt lgkmcnt(2)
  v_mfma_f32_32x32x16_bf16 v[192:207], v[16:19], v[144:147], 0
  ds_read_b128 v[156:159], v7 offset:0
  v_mfma_f32_32x32x16_bf16 v[208:223], v[20:23], v[144:147], 0
  s_waitcnt lgkmcnt(2)
  v_mfma_f32_32x32x16_bf16 v[192:207], v[24:27], v[148:151], v[192:207]
  ds_read_b128 v[144:147], v8 offset:0
  v_mfma_f32_32x32x16_bf16 v[208:223], v[28:31], v[148:151], v[208:223]
  s_waitcnt lgkmcnt(2)
  v_mfma_f32_32x32x16_bf16 v[192:207], v[32:35], v[152:155], v[192:207]
  ds_read_b128 v[148:151], v9 offset:0
  v_mfma_f32_32x32x16_bf16 v[208:223], v[36:39], v[152:155], v[208:223]
  s_waitcnt lgkmcnt(2)
  v_mfma_f32_32x32x16_bf16 v[192:207], v[40:43], v[156:159], v[192:207]
  ds_read_b128 v[152:155], v10 offset:0
  v_mfma_f32_32x32x16_bf16 v[208:223], v[44:47], v[156:159], v[208:223]
  s_waitcnt lgkmcnt(2)
  v_mfma_f32_32x32x16_bf16 v[192:207], v[48:51], v[144:147], v[192:207]
  ds_read_b128 v[156:159], v11 offset:0
  v_mfma_f32_32x32x16_bf16 v[208:223], v[52:55], v[144:147], v[208:223]
  s_waitcnt lgkmcnt(2)
  v_mfma_f32_32x32x16_bf16 v[192:207], v[56:59], v[148:151], v[192:207]
  ds_read_b128 v[144:147], v4 offset:256
  v_mfma_f32_32x32x16_bf16 v[208:223], v[60:63], v[148:151], v[208:223]
  s_waitcnt lgkmcnt(2)
  v_mfma_f32_32x32x16_bf16 v[192:207], v[64:67], v[152:155], v[192:207]
  ds_read_b128 v[148:151], v5 offset:256
  v_mfma_f32_32x32x16_bf16 v[208:223], v[68:71], v[152:155], v[208:223]
  s_waitcnt lgkmcnt(2)
  v_mfma_f32_32x32x16_bf16 v[192:207], v[72:75], v[156:159], v[192:207]
  ds_read_b128 v[152:155], v6 offset:256
  v_mfma_f32_32x32x16_bf16 v[208:223], v[76:79], v[156:159], v[208:223]
  s_waitcnt lgkmcnt(2)
  v_mfma_f32_32x32x16_bf16 v[192:207], v[80:83], v[144:147], v[192:207]
  ds_read_b128 v[156:159], v7 offset:256
  v_mfma_f32_32x32x16_bf16 v[208:223], v[84:87], v[144:147], v[208:223]
  s_waitcnt lgkmcnt(2)
  v_mfma_f32_32x32x16_bf16 v[192:207], v[88:91], v[148:151], v[192:207]
  ds_read_b128 v[144:147], v8 offset:256
  v_mfma_f32_32x32x16_bf16 v[208:223], v[92:95], v[148:151], v[208:223]
  s_waitcnt lgkmcnt(2)
  v_mfma_f32_32x32x16_bf16 v[192:207], v[96:99], v[152:155], v[192:207]
  ds_read_b128 v[148:151], v9 offset:256
  v_mfma_f32_32x32x16_bf16 v[208:223], v[100:103], v[152:155], v[208:223]
  s_waitcnt lgkmcnt(2)
  v_mfma_f32_32x32x16_bf16 v[192:207], v[104:107], v[156:159], v[192:207]
  ds_read_b128 v[152:155], v10 offset:256
  v_mfma_f32_32x32x16_bf16 v[208:223], v[108:111], v[156:159], v[208:223]
  s_waitcnt lgkmcnt(2)
  v_mfma_f32_32x32x16_bf16 v[192:207], v[112:115], v[144:147], v[192:207]
  ds_read_b128 v[156:159], v11 offset:256
  v_mfma_f32_32x32x16_bf16 v[208:223], v[116:119], v[144:147], v[208:223]
  s_waitcnt lgkmcnt(2)
  v_mfma_f32_32x32x16_bf16 v[192:207], v[120:123], v[148:151], v[192:207]
  s_barrier
  ds_read_b128 v[144:147], v4 offset:16384
  v_mfma_f32_32x32x16_bf16 v[208:223], v[124:127], v[148:151], v[208:223]
  s_waitcnt lgkmcnt(2)
  v_mfma_f32_32x32x16_bf16 v[192:207], v[128:131], v[152:155], v[192:207]
  ds_read_b128 v[148:151], v5 offset:16384
  v_mfma_f32_32x32x16_bf16 v[208:223], v[132:135], v[152:155], v[208:223]
  s_waitcnt lgkmcnt(2)
  v_mfma_f32_32x32x16_bf16 v[192:207], v[136:139], v[156:159], v[192:207]
  ds_read_b128 v[152:155], v6 offset:16384
  v_mfma_f32_32x32x16_bf16 v[208:223], v[140:143], v[156:159], v[208:223]
  s_waitcnt lgkmcnt(2)
  v_mfma_f32_32x32x16_bf16 v[224:239], v[16:19], v[144:147], 0
  ds_read_b128 v[156:159], v7 offset:16384
  v_mfma_f32_32x32x16_bf16 v[240:255], v[20:23], v[144:147], 0
  s_waitcnt lgkmcnt(2)
  v_mfma_f32_32x32x16_bf16 v[224:239], v[24:27], v[148:151], v[224:239]
  ds_read_b128 v[144:147], v8 offset:16384
  v_mfma_f32_32x32x16_bf16 v[240:255], v[28:31], v[148:151], v[240:255]
  s_waitcnt lgkmcnt(2)
  v_mfma_f32_32x32x16_bf16 v[224:239], v[32:35], v[152:155], v[224:239]
  ds_read_b128 v[148:151], v9 offset:16384
  v_mfma_f32_32x32x16_bf16 v[240:255], v[36:39], v[152:155], v[240:255]
  s_waitcnt lgkmcnt(2)
  v_mfma_f32_32x32x16_bf16 v[224:239], v[40:43], v[156:159], v[224:239]
  ds_read_b128 v[152:155], v10 offset:16384
  v_cvt_pk_bf16_f32 v160, v192, v208
  v_cvt_pk_bf16_f32 v161, v193, v209
  v_mfma_f32_32x32x16_bf16 v[240:255], v[44:47], v[156:159], v[240:255]
  v_cvt_pk_bf16_f32 v164, v194, v210
  v_cvt_pk_bf16_f32 v165, v195, v211
  s_waitcnt lgkmcnt(2)
  v_mfma_f32_32x32x16_bf16 v[224:239], v[48:51], v[144:147], v[224:239]
  ds_read_b128 v[156:159], v11 offset:16384
  v_cvt_pk_bf16_f32 v168, v196, v212
  v_cvt_pk_bf16_f32 v169, v197, v213
  v_mfma_f32_32x32x16_bf16 v[240:255], v[52:55], v[144:147], v[240:255]
  v_cvt_pk_bf16_f32 v172, v198, v214
  v_cvt_pk_bf16_f32 v173, v199, v215
  s_waitcnt lgkmcnt(2)
  v_mfma_f32_32x32x16_bf16 v[224:239], v[56:59], v[148:151], v[224:239]
  ds_read_b128 v[144:147], v4 offset:16640
  v_permlane16_swap_b32 v160, v161
  v_permlane16_swap_b32 v164, v165
  v_mfma_f32_32x32x16_bf16 v[240:255], v[60:63], v[148:151], v[240:255]
  v_permlane16_swap_b32 v168, v169
  v_permlane16_swap_b32 v172, v173
  s_waitcnt lgkmcnt(2)
  v_mfma_f32_32x32x16_bf16 v[224:239], v[64:67], v[152:155], v[224:239]
  ds_read_b128 v[148:151], v5 offset:16640
  v_cvt_pk_bf16_f32 v176, v200, v216
  v_cvt_pk_bf16_f32 v177, v201, v217
  v_mfma_f32_32x32x16_bf16 v[240:255], v[68:71], v[152:155], v[240:255]
  v_cvt_pk_bf16_f32 v180, v202, v218
  v_cvt_pk_bf16_f32 v181, v203, v219
  s_waitcnt lgkmcnt(2)
  v_mfma_f32_32x32x16_bf16 v[224:239], v[72:75], v[156:159], v[224:239]
  ds_read_b128 v[152:155], v6 offset:16640
  v_cvt_pk_bf16_f32 v184, v204, v220
  v_cvt_pk_bf16_f32 v185, v205, v221
  v_mfma_f32_32x32x16_bf16 v[240:255], v[76:79], v[156:159], v[240:255]
  v_cvt_pk_bf16_f32 v188, v206, v222
  v_cvt_pk_bf16_f32 v189, v207, v223
  s_waitcnt lgkmcnt(2)
  v_mfma_f32_32x32x16_bf16 v[224:239], v[80:83], v[144:147], v[224:239]
  ds_read_b128 v[156:159], v7 offset:16640
  v_permlane16_swap_b32 v176, v177
  v_permlane16_swap_b32 v180, v181
  v_mfma_f32_32x32x16_bf16 v[240:255], v[84:87], v[144:147], v[240:255]
  v_permlane16_swap_b32 v184, v185
  v_permlane16_swap_b32 v188, v189
  s_waitcnt lgkmcnt(2)
  v_mfma_f32_32x32x16_bf16 v[224:239], v[88:91], v[148:151], v[224:239]
  ds_read_b128 v[144:147], v8 offset:16640
  v_mfma_f32_32x32x16_bf16 v[240:255], v[92:95], v[148:151], v[240:255]
  s_waitcnt lgkmcnt(2)
  v_mfma_f32_32x32x16_bf16 v[224:239], v[96:99], v[152:155], v[224:239]
  ds_read_b128 v[148:151], v9 offset:16640
  v_mfma_f32_32x32x16_bf16 v[240:255], v[100:103], v[152:155], v[240:255]
  s_waitcnt lgkmcnt(2)
  v_mfma_f32_32x32x16_bf16 v[224:239], v[104:107], v[156:159], v[224:239]
  ds_read_b128 v[152:155], v10 offset:16640
  v_mfma_f32_32x32x16_bf16 v[240:255], v[108:111], v[156:159], v[240:255]
  s_waitcnt lgkmcnt(2)
  v_mfma_f32_32x32x16_bf16 v[224:239], v[112:115], v[144:147], v[224:239]
  ds_read_b128 v[156:159], v11 offset:16640
  v_mfma_f32_32x32x16_bf16 v[240:255], v[116:119], v[144:147], v[240:255]
  s_waitcnt lgkmcnt(2)
  v_mfma_f32_32x32x16_bf16 v[224:239], v[120:123], v[148:151], v[224:239]
  s_barrier
  ds_read_b128 v[144:147], v4 offset:32768
  v_mfma_f32_32x32x16_bf16 v[240:255], v[124:127], v[148:151], v[240:255]
  s_waitcnt lgkmcnt(2)
  v_mfma_f32_32x32x16_bf16 v[224:239], v[128:131], v[152:155], v[224:239]
  ds_read_b128 v[148:151], v5 offset:32768
  v_mfma_f32_32x32x16_bf16 v[240:255], v[132:135], v[152:155], v[240:255]
  s_waitcnt lgkmcnt(2)
  v_mfma_f32_32x32x16_bf16 v[224:239], v[136:139], v[156:159], v[224:239]
  ds_read_b128 v[152:155], v6 offset:32768
  v_mfma_f32_32x32x16_bf16 v[240:255], v[140:143], v[156:159], v[240:255]
  s_waitcnt lgkmcnt(2)
  v_mfma_f32_32x32x16_bf16 v[192:207], v[16:19], v[144:147], 0
  ds_read_b128 v[156:159], v7 offset:32768
  v_mfma_f32_32x32x16_bf16 v[208:223], v[20:23], v[144:147], 0
  s_waitcnt lgkmcnt(2)
  v_mfma_f32_32x32x16_bf16 v[192:207], v[24:27], v[148:151], v[192:207]
  ds_read_b128 v[144:147], v8 offset:32768
  v_mfma_f32_32x32x16_bf16 v[208:223], v[28:31], v[148:151], v[208:223]
  s_waitcnt lgkmcnt(2)
  v_mfma_f32_32x32x16_bf16 v[192:207], v[32:35], v[152:155], v[192:207]
  ds_read_b128 v[148:151], v9 offset:32768
  v_mfma_f32_32x32x16_bf16 v[208:223], v[36:39], v[152:155], v[208:223]
  s_waitcnt lgkmcnt(2)
  v_mfma_f32_32x32x16_bf16 v[192:207], v[40:43], v[156:159], v[192:207]
  ds_read_b128 v[152:155], v10 offset:32768
  v_cvt_pk_bf16_f32 v162, v224, v240
  v_cvt_pk_bf16_f32 v163, v225, v241
  v_mfma_f32_32x32x16_bf16 v[208:223], v[44:47], v[156:159], v[208:223]
  v_cvt_pk_bf16_f32 v166, v226, v242
  v_cvt_pk_bf16_f32 v167, v227, v243
  s_waitcnt lgkmcnt(2)
  v_mfma_f32_32x32x16_bf16 v[192:207], v[48:51], v[144:147], v[192:207]
  ds_read_b128 v[156:159], v11 offset:32768
  v_cvt_pk_bf16_f32 v170, v228, v244
  v_cvt_pk_bf16_f32 v171, v229, v245
  v_mfma_f32_32x32x16_bf16 v[208:223], v[52:55], v[144:147], v[208:223]
  v_cvt_pk_bf16_f32 v174, v230, v246
  v_cvt_pk_bf16_f32 v175, v231, v247
  s_waitcnt lgkmcnt(2)
  v_mfma_f32_32x32x16_bf16 v[192:207], v[56:59], v[148:151], v[192:207]
  ds_read_b128 v[144:147], v4 offset:33024
  v_permlane16_swap_b32 v162, v163
  s_add_u32 s55, s57, 0
  buffer_store_dwordx4 v[160:163], v12, s[20:23], s55 offen sc1
  v_mfma_f32_32x32x16_bf16 v[208:223], v[60:63], v[148:151], v[208:223]
  v_permlane16_swap_b32 v166, v167
  s_add_u32 s55, s57, 33792
  buffer_store_dwordx4 v[164:167], v12, s[20:23], s55 offen sc1
  s_waitcnt lgkmcnt(2)
  v_mfma_f32_32x32x16_bf16 v[192:207], v[64:67], v[152:155], v[192:207]
  ds_read_b128 v[148:151], v5 offset:33024
  v_permlane16_swap_b32 v170, v171
  s_add_u32 s55, s57, 135168
  buffer_store_dwordx4 v[168:171], v12, s[20:23], s55 offen sc1
  v_mfma_f32_32x32x16_bf16 v[208:223], v[68:71], v[152:155], v[208:223]
  v_permlane16_swap_b32 v174, v175
  s_add_u32 s55, s57, 168960
  buffer_store_dwordx4 v[172:175], v12, s[20:23], s55 offen sc1
  s_waitcnt lgkmcnt(2)
  v_mfma_f32_32x32x16_bf16 v[192:207], v[72:75], v[156:159], v[192:207]
  ds_read_b128 v[152:155], v6 offset:33024
  v_cvt_pk_bf16_f32 v178, v232, v248
  v_cvt_pk_bf16_f32 v179, v233, v249
  v_mfma_f32_32x32x16_bf16 v[208:223], v[76:79], v[156:159], v[208:223]
  v_cvt_pk_bf16_f32 v182, v234, v250
  v_cvt_pk_bf16_f32 v183, v235, v251
  s_waitcnt lgkmcnt(2)
  v_mfma_f32_32x32x16_bf16 v[192:207], v[80:83], v[144:147], v[192:207]
  ds_read_b128 v[156:159], v7 offset:33024
  v_cvt_pk_bf16_f32 v186, v236, v252
  v_cvt_pk_bf16_f32 v187, v237, v253
  v_mfma_f32_32x32x16_bf16 v[208:223], v[84:87], v[144:147], v[208:223]
  v_cvt_pk_bf16_f32 v190, v238, v254
  v_cvt_pk_bf16_f32 v191, v239, v255
  s_waitcnt lgkmcnt(2)
  v_mfma_f32_32x32x16_bf16 v[192:207], v[88:91], v[148:151], v[192:207]
  ds_read_b128 v[144:147], v8 offset:33024
  v_permlane16_swap_b32 v178, v179
  s_add_u32 s55, s57, 270336
  buffer_store_dwordx4 v[176:179], v12, s[20:23], s55 offen sc1
  v_mfma_f32_32x32x16_bf16 v[208:223], v[92:95], v[148:151], v[208:223]
  v_permlane16_swap_b32 v182, v183
  s_add_u32 s55, s57, 304128
  buffer_store_dwordx4 v[180:183], v12, s[20:23], s55 offen sc1
  s_waitcnt lgkmcnt(2)
  v_mfma_f32_32x32x16_bf16 v[192:207], v[96:99], v[152:155], v[192:207]
  ds_read_b128 v[148:151], v9 offset:33024
  v_permlane16_swap_b32 v186, v187
  s_add_u32 s55, s57, 405504
  buffer_store_dwordx4 v[184:187], v12, s[20:23], s55 offen sc1
  v_mfma_f32_32x32x16_bf16 v[208:223], v[100:103], v[152:155], v[208:223]
  v_permlane16_swap_b32 v190, v191
  s_add_u32 s55, s57, 439296
  buffer_store_dwordx4 v[188:191], v12, s[20:23], s55 offen sc1
  s_waitcnt lgkmcnt(2)
  v_mfma_f32_32x32x16_bf16 v[192:207], v[104:107], v[156:159], v[192:207]
  ds_read_b128 v[152:155], v10 offset:33024
  v_mfma_f32_32x32x16_bf16 v[208:223], v[108:111], v[156:159], v[208:223]
  s_waitcnt lgkmcnt(2)
  v_mfma_f32_32x32x16_bf16 v[192:207], v[112:115], v[144:147], v[192:207]
  ds_read_b128 v[156:159], v11 offset:33024
  v_mfma_f32_32x32x16_bf16 v[208:223], v[116:119], v[144:147], v[208:223]
  s_waitcnt lgkmcnt(2)
  v_mfma_f32_32x32x16_bf16 v[192:207], v[120:123], v[148:151], v[192:207]
  s_barrier
  ds_read_b128 v[144:147], v4 offset:49152
  v_mfma_f32_32x32x16_bf16 v[208:223], v[124:127], v[148:151], v[208:223]
  s_waitcnt lgkmcnt(2)
  v_mfma_f32_32x32x16_bf16 v[192:207], v[128:131], v[152:155], v[192:207]
  ds_read_b128 v[148:151], v5 offset:49152
  v_mfma_f32_32x32x16_bf16 v[208:223], v[132:135], v[152:155], v[208:223]
  s_waitcnt lgkmcnt(2)
  v_mfma_f32_32x32x16_bf16 v[192:207], v[136:139], v[156:159], v[192:207]
  ds_read_b128 v[152:155], v6 offset:49152
  v_mfma_f32_32x32x16_bf16 v[208:223], v[140:143], v[156:159], v[208:223]
  s_waitcnt lgkmcnt(2)
  v_mfma_f32_32x32x16_bf16 v[224:239], v[16:19], v[144:147], 0
  ds_read_b128 v[156:159], v7 offset:49152
  v_mfma_f32_32x32x16_bf16 v[240:255], v[20:23], v[144:147], 0
  s_waitcnt lgkmcnt(2)
  v_mfma_f32_32x32x16_bf16 v[224:239], v[24:27], v[148:151], v[224:239]
  ds_read_b128 v[144:147], v8 offset:49152
  v_mfma_f32_32x32x16_bf16 v[240:255], v[28:31], v[148:151], v[240:255]
  s_waitcnt lgkmcnt(2)
  v_mfma_f32_32x32x16_bf16 v[224:239], v[32:35], v[152:155], v[224:239]
  ds_read_b128 v[148:151], v9 offset:49152
  v_mfma_f32_32x32x16_bf16 v[240:255], v[36:39], v[152:155], v[240:255]
  s_waitcnt lgkmcnt(2)
  v_mfma_f32_32x32x16_bf16 v[224:239], v[40:43], v[156:159], v[224:239]
  ds_read_b128 v[152:155], v10 offset:49152
  v_cvt_pk_bf16_f32 v160, v192, v208
  v_cvt_pk_bf16_f32 v161, v193, v209
  v_mfma_f32_32x32x16_bf16 v[240:255], v[44:47], v[156:159], v[240:255]
  v_cvt_pk_bf16_f32 v164, v194, v210
  v_cvt_pk_bf16_f32 v165, v195, v211
  s_waitcnt lgkmcnt(2)
  v_mfma_f32_32x32x16_bf16 v[224:239], v[48:51], v[144:147], v[224:239]
  ds_read_b128 v[156:159], v11 offset:49152
  v_cvt_pk_bf16_f32 v168, v196, v212
  v_cvt_pk_bf16_f32 v169, v197, v213
  v_mfma_f32_32x32x16_bf16 v[240:255], v[52:55], v[144:147], v[240:255]
  v_cvt_pk_bf16_f32 v172, v198, v214
  v_cvt_pk_bf16_f32 v173, v199, v215
  s_waitcnt lgkmcnt(2)
  v_mfma_f32_32x32x16_bf16 v[224:239], v[56:59], v[148:151], v[224:239]
  ds_read_b128 v[144:147], v4 offset:49408
  v_permlane16_swap_b32 v160, v161
  v_permlane16_swap_b32 v164, v165
  v_mfma_f32_32x32x16_bf16 v[240:255], v[60:63], v[148:151], v[240:255]
  v_permlane16_swap_b32 v168, v169
  v_permlane16_swap_b32 v172, v173
  s_waitcnt lgkmcnt(2)
  v_mfma_f32_32x32x16_bf16 v[224:239], v[64:67], v[152:155], v[224:239]
  ds_read_b128 v[148:151], v5 offset:49408
  v_cvt_pk_bf16_f32 v176, v200, v216
  v_cvt_pk_bf16_f32 v177, v201, v217
  v_mfma_f32_32x32x16_bf16 v[240:255], v[68:71], v[152:155], v[240:255]
  v_cvt_pk_bf16_f32 v180, v202, v218
  v_cvt_pk_bf16_f32 v181, v203, v219
  s_waitcnt lgkmcnt(2)
  v_mfma_f32_32x32x16_bf16 v[224:239], v[72:75], v[156:159], v[224:239]
  ds_read_b128 v[152:155], v6 offset:49408
  v_cvt_pk_bf16_f32 v184, v204, v220
  v_cvt_pk_bf16_f32 v185, v205, v221
  v_mfma_f32_32x32x16_bf16 v[240:255], v[76:79], v[156:159], v[240:255]
  v_cvt_pk_bf16_f32 v188, v206, v222
  v_cvt_pk_bf16_f32 v189, v207, v223
  s_waitcnt lgkmcnt(2)
  v_mfma_f32_32x32x16_bf16 v[224:239], v[80:83], v[144:147], v[224:239]
  ds_read_b128 v[156:159], v7 offset:49408
  v_permlane16_swap_b32 v176, v177
  v_permlane16_swap_b32 v180, v181
  v_mfma_f32_32x32x16_bf16 v[240:255], v[84:87], v[144:147], v[240:255]
  v_permlane16_swap_b32 v184, v185
  v_permlane16_swap_b32 v188, v189
  s_waitcnt lgkmcnt(2)
  v_mfma_f32_32x32x16_bf16 v[224:239], v[88:91], v[148:151], v[224:239]
  ds_read_b128 v[144:147], v8 offset:49408
  v_mfma_f32_32x32x16_bf16 v[240:255], v[92:95], v[148:151], v[240:255]
  s_waitcnt lgkmcnt(2)
  v_mfma_f32_32x32x16_bf16 v[224:239], v[96:99], v[152:155], v[224:239]
  ds_read_b128 v[148:151], v9 offset:49408
  v_mfma_f32_32x32x16_bf16 v[240:255], v[100:103], v[152:155], v[240:255]
  s_waitcnt lgkmcnt(2)
  v_mfma_f32_32x32x16_bf16 v[224:239], v[104:107], v[156:159], v[224:239]
  ds_read_b128 v[152:155], v10 offset:49408
  v_mfma_f32_32x32x16_bf16 v[240:255], v[108:111], v[156:159], v[240:255]
  s_waitcnt lgkmcnt(2)
  v_mfma_f32_32x32x16_bf16 v[224:239], v[112:115], v[144:147], v[224:239]
  ds_read_b128 v[156:159], v11 offset:49408
  v_mfma_f32_32x32x16_bf16 v[240:255], v[116:119], v[144:147], v[240:255]
  s_waitcnt lgkmcnt(2)
  v_mfma_f32_32x32x16_bf16 v[224:239], v[120:123], v[148:151], v[224:239]
  v_mfma_f32_32x32x16_bf16 v[240:255], v[124:127], v[148:151], v[240:255]
  s_waitcnt lgkmcnt(1)
  v_mfma_f32_32x32x16_bf16 v[224:239], v[128:131], v[152:155], v[224:239]
  v_mfma_f32_32x32x16_bf16 v[240:255], v[132:135], v[152:155], v[240:255]
  s_waitcnt lgkmcnt(0)
  v_mfma_f32_32x32x16_bf16 v[224:239], v[136:139], v[156:159], v[224:239]
  v_mfma_f32_32x32x16_bf16 v[240:255], v[140:143], v[156:159], v[240:255]
  v_lshrrev_b32 v1, 3, v0
  v_lshlrev_b32 v1, 10, v1
  v_lshrrev_b32 v2, 4, v0
  v_lshlrev_b32 v2, 1, v2
  v_and_b32 v4, 7, v0
  v_xor_b32 v2, v2, v4
  v_lshl_add_u32 v1, v2, 4, v1
  s_lshl_b32 s55, s84, 7
  s_lshl_b32 s56, s49, 15
  s_add_u32 s55, s55, s56
  s_mul_i32 s56, s52, 917504
  s_add_u32 s55, s55, s56
  v_add_u32 v4, s55, v1
  v_add_u32 v5, 7168, v4
  v_add_u32 v6, 14336, v4
  v_add_u32 v7, 21504, v4
  s_and_b32 s85, s50, 3
  s_mul_i32 s85, s85, 2
  s_add_u32 s85, s85, s51
  s_sub_u32 s55, s85, 7
  s_cselect_b32 s85, s85, s55
  s_sub_u32 s55, s85, 7
  s_cselect_b32 s85, s85, s55
  s_mul_i32 s87, s49, 12288
  s_add_u32 s87, s87, 98304
  s_lshr_b32 s88, s49, 1
  s_mul_i32 s88, s88, 4
  s_add_u32 s88, s88, s49
  s_add_u32 s88, s88, 2
  s_lshl_b32 s88, s88, 13
  v_cvt_pk_bf16_f32 v162, v224, v240
  v_cvt_pk_bf16_f32 v163, v225, v241
  v_cvt_pk_bf16_f32 v166, v226, v242
  v_cvt_pk_bf16_f32 v167, v227, v243
  v_cvt_pk_bf16_f32 v170, v228, v244
  v_cvt_pk_bf16_f32 v171, v229, v245
  v_cvt_pk_bf16_f32 v174, v230, v246
  v_cvt_pk_bf16_f32 v175, v231, v247
  v_permlane16_swap_b32 v162, v163
  s_add_u32 s55, s58, 256
  buffer_store_dwordx4 v[160:163], v12, s[20:23], s55 offen sc1
  v_permlane16_swap_b32 v166, v167
  s_add_u32 s55, s58, 34048
  buffer_store_dwordx4 v[164:167], v12, s[20:23], s55 offen sc1
  v_permlane16_swap_b32 v170, v171
  s_add_u32 s55, s58, 135424
  buffer_store_dwordx4 v[168:171], v12, s[20:23], s55 offen sc1
  v_permlane16_swap_b32 v174, v175
  s_add_u32 s55, s58, 169216
  buffer_store_dwordx4 v[172:175], v12, s[20:23], s55 offen sc1
  v_cvt_pk_bf16_f32 v178, v232, v248
  v_cvt_pk_bf16_f32 v179, v233, v249
  v_cvt_pk_bf16_f32 v182, v234, v250
  v_cvt_pk_bf16_f32 v183, v235, v251
  v_cvt_pk_bf16_f32 v186, v236, v252
  v_cvt_pk_bf16_f32 v187, v237, v253
  v_cvt_pk_bf16_f32 v190, v238, v254
  v_cvt_pk_bf16_f32 v191, v239, v255
  v_permlane16_swap_b32 v178, v179
  s_add_u32 s55, s58, 270592
  buffer_store_dwordx4 v[176:179], v12, s[20:23], s55 offen sc1
  v_permlane16_swap_b32 v182, v183
  s_add_u32 s55, s58, 304384
  buffer_store_dwordx4 v[180:183], v12, s[20:23], s55 offen sc1
  v_permlane16_swap_b32 v186, v187
  s_add_u32 s55, s58, 405760
  buffer_store_dwordx4 v[184:187], v12, s[20:23], s55 offen sc1
  v_permlane16_swap_b32 v190, v191
  s_add_u32 s55, s58, 439552
  buffer_store_dwordx4 v[188:191], v12, s[20:23], s55 offen sc1
  s_lshl_b32 s55, s52, 8
  s_add_u32 s55, s55, 32768
  s_waitcnt vmcnt(0)
  v_mov_b32 v2, s82
  v_mov_b32 v1, 1
  s_mov_b64 exec, 1
  ds_add_rtn_u32 v1, v2, v1 offset:20
  s_waitcnt lgkmcnt(0)
  v_cmp_ne_u32 vcc, 3, v1
  s_mov_b64 exec, -1
  s_cbranch_vccnz LS21
  s_atomic_add s81, s[6:7], s55
  s_atomic_add s81, s[6:7], s55 offset:0x200
  s_atomic_add s81, s[6:7], s55 offset:0x400
  s_atomic_add s81, s[6:7], s55 offset:0x600
  s_atomic_add s81, s[6:7], s55 offset:0x800
  s_atomic_add s81, s[6:7], s55 offset:0xa00
  s_atomic_add s81, s[6:7], s55 offset:0xc00
  s_atomic_add s81, s[6:7], s55 offset:0xe00
LS21:
  s_add_u32 m0, s87, 0
  s_add_u32 s86, s85, 0
  s_sub_u32 s92, s86, 7
  s_cselect_b32 s86, s86, s92
  s_lshl_b32 s86, s86, 17
  buffer_load_dwordx4 v4, s[24:27], s86 offen offset:0 lds
  buffer_load_dwordx4 v5, s[24:27], s86 offen offset:1024 lds
  buffer_load_dwordx4 v6, s[24:27], s86 offen offset:2048 lds
  buffer_load_dwordx4 v7, s[24:27], s86 offen offset:3072 lds
  s_add_u32 m0, s87, 4096
  s_add_u32 s86, s85, 1
  s_sub_u32 s92, s86, 7
  s_cselect_b32 s86, s86, s92
  s_lshl_b32 s86, s86, 17
  buffer_load_dwordx4 v4, s[24:27], s86 offen offset:0 lds
  buffer_load_dwordx4 v5, s[24:27], s86 offen offset:1024 lds
  buffer_load_dwordx4 v6, s[24:27], s86 offen offset:2048 lds
  buffer_load_dwordx4 v7, s[24:27], s86 offen offset:3072 lds
  s_add_u32 m0, s87, 8192
  s_add_u32 s86, s85, 2
  s_sub_u32 s92, s86, 7
  s_cselect_b32 s86, s86, s92
  s_lshl_b32 s86, s86, 17
  buffer_load_dwordx4 v4, s[24:27], s86 offen offset:0 lds
  buffer_load_dwordx4 v5, s[24:27], s86 offen offset:1024 lds
  buffer_load_dwordx4 v6, s[24:27], s86 offen offset:2048 lds
  buffer_load_dwordx4 v7, s[24:27], s86 offen offset:3072 lds
  v_mov_b32 v2, s82
  s_mov_b32 s63, 0x800000
  s_mov_b64 exec, 1
W22:
  ds_read_b32 v1, v2 offset:20
  s_sub_u32 s63, s63, 1
  s_cbranch_scc1 WX22
  s_waitcnt lgkmcnt(0)
  v_cmp_gt_u32 vcc, 4, v1
  s_nop 0
  s_cbranch_vccnz W22
WX22:
  s_mov_b64 exec, -1
  s_add_u32 m0, s88, 0
  s_add_u32 s86, s85, 3
  s_sub_u32 s92, s86, 7
  s_cselect_b32 s86, s86, s92
  s_lshl_b32 s86, s86, 17
  buffer_load_dwordx4 v4, s[24:27], s86 offen offset:0 lds
  buffer_load_dwordx4 v5, s[24:27], s86 offen offset:1024 lds
  buffer_load_dwordx4 v6, s[24:27], s86 offen offset:2048 lds
  buffer_load_dwordx4 v7, s[24:27], s86 offen offset:3072 lds
  s_add_u32 m0, s88, 4096
  s_add_u32 s86, s85, 4
  s_sub_u32 s92, s86, 7
  s_cselect_b32 s86, s86, s92
  s_lshl_b32 s86, s86, 17
  buffer_load_dwordx4 v4, s[24:27], s86 offen offset:0 lds
  buffer_load_dwordx4 v5, s[24:27], s86 offen offset:1024 lds
  buffer_load_dwordx4 v6, s[24:27], s86 offen offset:2048 lds
  buffer_load_dwordx4 v7, s[24:27], s86 offen offset:3072 lds
  s_add_u32 m0, s88, 16384
  s_add_u32 s86, s85, 5
  s_sub_u32 s92, s86, 7
  s_cselect_b32 s86, s86, s92
  s_lshl_b32 s86, s86, 17
  buffer_load_dwordx4 v4, s[24:27], s86 offen offset:0 lds
  buffer_load_dwordx4 v5, s[24:27], s86 offen offset:1024 lds
  buffer_load_dwordx4 v6, s[24:27], s86 offen offset:2048 lds
  buffer_load_dwordx4 v7, s[24:27], s86 offen offset:3072 lds
  s_add_u32 m0, s88, 20480
  s_add_u32 s86, s85, 6
  s_sub_u32 s92, s86, 7
  s_cselect_b32 s86, s86, s92
  s_lshl_b32 s86, s86, 17
  buffer_load_dwordx4 v4, s[24:27], s86 offen offset:0 lds
  buffer_load_dwordx4 v5, s[24:27], s86 offen offset:1024 lds
  buffer_load_dwordx4 v6, s[24:27], s86 offen offset:2048 lds
  buffer_load_dwordx4 v7, s[24:27], s86 offen offset:3072 lds
  v_mov_b32 v2, s82
  v_mov_b32 v1, 1
  s_mov_b64 exec, 1
  ds_add_u32 v2, v1 offset:28
  s_mov_b64 exec, -1
  s_mov_b32 s95, 0
  s_waitcnt vmcnt(0)
  s_branch L_bpart
L_dfth:
  v_lshrrev_b32 v1, 5, v0
  v_and_b32 v2, 31, v0
  v_lshlrev_b32 v4, 10, v1
  v_lshl_add_u32 v4, v2, 4, v4
  s_and_b32 s55, s49, 2
  s_add_u32 s78, s55, s49
  s_lshl_b32 s56, s50, 4
  s_add_u32 s78, s78, s56
  s_lshl_b32 s55, s78, 13
  s_lshl_b32 s71, s52, 14
  v_add_u32 v4, s55, v4
  s_waitcnt lgkmcnt(0)
  s_xor_b32 s55, s71, 0
  buffer_load_dwordx4 v[16:19], v4, s[8:11], s55 offen offset:0
  buffer_load_dwordx4 v[20:23], v4, s[8:11], s55 offen offset:512
  s_xor_b32 s55, s71, 2048
  buffer_load_dwordx4 v[24:27], v4, s[8:11], s55 offen offset:0
  buffer_load_dwordx4 v[28:31], v4, s[8:11], s55 offen offset:512
  s_xor_b32 s55, s71, 4096
  buffer_load_dwordx4 v[32:35], v4, s[8:11], s55 offen offset:0
  buffer_load_dwordx4 v[36:39], v4, s[8:11], s55 offen offset:512
  s_xor_b32 s55, s71, 6144
  buffer_load_dwordx4 v[40:43], v4, s[8:11], s55 offen offset:0
  buffer_load_dwordx4 v[44:47], v4, s[8:11], s55 offen offset:512
  s_load_dwordx2 s[24:25], s[0:1], 48
  s_mov_b32 s26, 1835008
  s_mov_b32 s27, 0x20000
  s_load_dwordx2 s[28:29], s[0:1], 64
  s_mov_b32 s30, 2097152
  s_mov_b32 s31, 0x20000
  s_load_dwordx2 s[32:33], s[0:1], 72
  s_mov_b32 s34, 256
  s_mov_b32 s35, 0x20000
  s_load_dwordx2 s[36:37], s[0:1], 8
  s_mov_b32 s38, 1052672
  s_mov_b32 s39, 0x20000
  s_load_dwordx2 s[40:41], s[0:1], 16
  s_mov_b32 s42, 1052672
  s_mov_b32 s43, 0x20000
  s_add_u32 s6, s20, 17891328
  s_addc_u32 s7, s21, 0
  s_mov_b32 s81, 1
  s_mov_b32 s82, 156160
  s_mov_b32 s83, 147456
  s_load_dwordx2 s[44:45], s[0:1], 56
  s_mov_b32 s46, 1024
  s_mov_b32 s47, 0x20000
  s_sub_u32 s73, s2, 224
  s_lshl_b32 s55, s49, 3
  v_add_u32 v1, s55, v1
  v_and_b32 v5, 15, v1
  v_xor_b32 v5, v5, v2
  v_lshlrev_b32 v5, 4, v5
  v_lshl_add_u32 v5, v1, 9, v5
  s_cmp_eq_u32 s52, 0
  s_cselect_b32 s64, 1.0, -1.0
  s_mov_b32 s65, s64
  v_lshlrev_b32 v11, 4, v2
  v_xor_b32 v6, 32, v5
  v_xor_b32 v7, 64, v5
  v_xor_b32 v8, 96, v5
  s_xor_b32 s55, s71, 65536
  buffer_load_dwordx4 v[48:51], v4, s[8:11], s55 offen offset:0
  buffer_load_dwordx4 v[52:55], v4, s[8:11], s55 offen offset:512
  s_xor_b32 s55, s71, 67584
  buffer_load_dwordx4 v[56:59], v4, s[8:11], s55 offen offset:0
  buffer_load_dwordx4 v[60:63], v4, s[8:11], s55 offen offset:512
  s_waitcnt lgkmcnt(0)
  s_waitcnt vmcnt(10)
  s_xor_b32 s55, s71, 69632
  buffer_load_dwordx4 v[64:67], v4, s[8:11], s55 offen offset:0
  buffer_load_dwordx4 v[68:71], v4, s[8:11], s55 offen offset:512
  v_lshlrev_b32 v152, 16, v16
  v_and_b32 v153, 0xffff0000, v16
  v_lshlrev_b32 v154, 16, v20
  v_and_b32 v155, 0xffff0000, v20
  v_lshlrev_b32 v156, 16, v17
  v_and_b32 v157, 0xffff0000, v17
  v_lshlrev_b32 v158, 16, v21
  v_and_b32 v159, 0xffff0000, v21
  v_fmac_f32 v152, s64, v154
  v_fmac_f32 v153, s64, v155
  v_fmac_f32 v156, s64, v158
  v_fmac_f32 v157, s64, v159
  v_cvt_pk_bf16_f32 v160, v152, v153
  v_cvt_pk_bf16_f32 v161, v156, v157
  v_lshlrev_b32 v152, 16, v18
  v_and_b32 v153, 0xffff0000, v18
  v_lshlrev_b32 v154, 16, v22
  v_and_b32 v155, 0xffff0000, v22
  v_lshlrev_b32 v156, 16, v19
  v_and_b32 v157, 0xffff0000, v19
  v_lshlrev_b32 v158, 16, v23
  v_and_b32 v159, 0xffff0000, v23
  v_fmac_f32 v152, s64, v154
  v_fmac_f32 v153, s64, v155
  v_fmac_f32 v156, s64, v158
  v_fmac_f32 v157, s64, v159
  v_cvt_pk_bf16_f32 v162, v152, v153
  v_cvt_pk_bf16_f32 v163, v156, v157
  ds_write_b128 v5, v[160:163] offset:0
  s_waitcnt vmcnt(10)
  s_xor_b32 s55, s71, 71680
  buffer_load_dwordx4 v[72:75], v4, s[8:11], s55 offen offset:0
  buffer_load_dwordx4 v[76:79], v4, s[8:11], s55 offen offset:512
  v_lshlrev_b32 v152, 16, v24
  v_and_b32 v153, 0xffff0000, v24
  v_lshlrev_b32 v154, 16, v28
  v_and_b32 v155, 0xffff0000, v28
  v_lshlrev_b32 v156, 16, v25
  v_and_b32 v157, 0xffff0000, v25
  v_lshlrev_b32 v158, 16, v29
  v_and_b32 v159, 0xffff0000, v29
  v_fmac_f32 v152, s64, v154
  v_fmac_f32 v153, s64, v155
  v_fmac_f32 v156, s64, v158
  v_fmac_f32 v157, s64, v159
  v_cvt_pk_bf16_f32 v164, v152, v153
  v_cvt_pk_bf16_f32 v165, v156, v157
  v_lshlrev_b32 v152, 16, v26
  v_and_b32 v153, 0xffff0000, v26
  v_lshlrev_b32 v154, 16, v30
  v_and_b32 v155, 0xffff0000, v30
  v_lshlrev_b32 v156, 16, v27
  v_and_b32 v157, 0xffff0000, v27
  v_lshlrev_b32 v158, 16, v31
  v_and_b32 v159, 0xffff0000, v31
  v_fmac_f32 v152, s64, v154
  v_fmac_f32 v153, s64, v155
  v_fmac_f32 v156, s64, v158
  v_fmac_f32 v157, s64, v159
  v_cvt_pk_bf16_f32 v166, v152, v153
  v_cvt_pk_bf16_f32 v167, v156, v157
  ds_write_b128 v6, v[164:167] offset:1024
  s_waitcnt vmcnt(10)
  s_xor_b32 s55, s71, 16384
  buffer_load_dwordx4 v[80:83], v4, s[8:11], s55 offen offset:0
  buffer_load_dwordx4 v[84:87], v4, s[8:11], s55 offen offset:512
  v_lshlrev_b32 v152, 16, v32
  v_and_b32 v153, 0xffff0000, v32
  v_lshlrev_b32 v154, 16, v36
  v_and_b32 v155, 0xffff0000, v36
  v_lshlrev_b32 v156, 16, v33
  v_and_b32 v157, 0xffff0000, v33
  v_lshlrev_b32 v158, 16, v37
  v_and_b32 v159, 0xffff0000, v37
  v_fmac_f32 v152, s64, v154
  v_fmac_f32 v153, s64, v155
  v_fmac_f32 v156, s64, v158
  v_fmac_f32 v157, s64, v159
  v_cvt_pk_bf16_f32 v160, v152, v153
  v_cvt_pk_bf16_f32 v161, v156, v157
  v_lshlrev_b32 v152, 16, v34
  v_and_b32 v153, 0xffff0000, v34
  v_lshlrev_b32 v154, 16, v38
  v_and_b32 v155, 0xffff0000, v38
  v_lshlrev_b32 v156, 16, v35
  v_and_b32 v157, 0xffff0000, v35
  v_lshlrev_b32 v158, 16, v39
  v_and_b32 v159, 0xffff0000, v39
  v_fmac_f32 v152, s64, v154
  v_fmac_f32 v153, s64, v155
  v_fmac_f32 v156, s64, v158
  v_fmac_f32 v157, s64, v159
  v_cvt_pk_bf16_f32 v162, v152, v153
  v_cvt_pk_bf16_f32 v163, v156, v157
  ds_write_b128 v7, v[160:163] offset:2048
  s_waitcnt vmcnt(10)
  s_xor_b32 s55, s71, 18432
  buffer_load_dwordx4 v[88:91], v4, s[8:11], s55 offen offset:0
  buffer_load_dwordx4 v[92:95], v4, s[8:11], s55 offen offset:512
  v_lshlrev_b32 v152, 16, v40
  v_and_b32 v153, 0xffff0000, v40
  v_lshlrev_b32 v154, 16, v44
  v_and_b32 v155, 0xffff0000, v44
  v_lshlrev_b32 v156, 16, v41
  v_and_b32 v157, 0xffff0000, v41
  v_lshlrev_b32 v158, 16, v45
  v_and_b32 v159, 0xffff0000, v45
  v_fmac_f32 v152, s64, v154
  v_fmac_f32 v153, s64, v155
  v_fmac_f32 v156, s64, v158
  v_fmac_f32 v157, s64, v159
  v_cvt_pk_bf16_f32 v164, v152, v153
  v_cvt_pk_bf16_f32 v165, v156, v157
  v_lshlrev_b32 v152, 16, v42
  v_and_b32 v153, 0xffff0000, v42
  v_lshlrev_b32 v154, 16, v46
  v_and_b32 v155, 0xffff0000, v46
  v_lshlrev_b32 v156, 16, v43
  v_and_b32 v157, 0xffff0000, v43
  v_lshlrev_b32 v158, 16, v47
  v_and_b32 v159, 0xffff0000, v47
  v_fmac_f32 v152, s64, v154
  v_fmac_f32 v153, s64, v155
  v_fmac_f32 v156, s64, v158
  v_fmac_f32 v157, s64, v159
  v_cvt_pk_bf16_f32 v166, v152, v153
  v_cvt_pk_bf16_f32 v167, v156, v157
  ds_write_b128 v8, v[164:167] offset:3072
  s_waitcnt lgkmcnt(0)
  s_barrier
  s_waitcnt vmcnt(10)
  s_xor_b32 s55, s71, 20480
  buffer_load_dwordx4 v[96:99], v4, s[8:11], s55 offen offset:0
  buffer_load_dwordx4 v[100:103], v4, s[8:11], s55 offen offset:512
  v_lshlrev_b32 v152, 16, v48
  v_and_b32 v153, 0xffff0000, v48
  v_lshlrev_b32 v154, 16, v52
  v_and_b32 v155, 0xffff0000, v52
  v_lshlrev_b32 v156, 16, v49
  v_and_b32 v157, 0xffff0000, v49
  v_lshlrev_b32 v158, 16, v53
  v_and_b32 v159, 0xffff0000, v53
  v_fmac_f32 v152, s64, v154
  v_fmac_f32 v153, s64, v155
  v_fmac_f32 v156, s64, v158
  v_fmac_f32 v157, s64, v159
  v_cvt_pk_bf16_f32 v160, v152, v153
  v_cvt_pk_bf16_f32 v161, v156, v157
  v_lshlrev_b32 v152, 16, v50
  v_and_b32 v153, 0xffff0000, v50
  v_lshlrev_b32 v154, 16, v54
  v_and_b32 v155, 0xffff0000, v54
  v_lshlrev_b32 v156, 16, v51
  v_and_b32 v157, 0xffff0000, v51
  v_lshlrev_b32 v158, 16, v55
  v_and_b32 v159, 0xffff0000, v55
  v_fmac_f32 v152, s64, v154
  v_fmac_f32 v153, s64, v155
  v_fmac_f32 v156, s64, v158
  v_fmac_f32 v157, s64, v159
  v_cvt_pk_bf16_f32 v162, v152, v153
  v_cvt_pk_bf16_f32 v163, v156, v157
  ds_write_b128 v5, v[160:163] offset:16384
  s_waitcnt vmcnt(10)
  s_xor_b32 s55, s71, 22528
  buffer_load_dwordx4 v[104:107], v4, s[8:11], s55 offen offset:0
  buffer_load_dwordx4 v[108:111], v4, s[8:11], s55 offen offset:512
  v_lshlrev_b32 v152, 16, v56
  v_and_b32 v153, 0xffff0000, v56
  v_lshlrev_b32 v154, 16, v60
  v_and_b32 v155, 0xffff0000, v60
  v_lshlrev_b32 v156, 16, v57
  v_and_b32 v157, 0xffff0000, v57
  v_lshlrev_b32 v158, 16, v61
  v_and_b32 v159, 0xffff0000, v61
  v_fmac_f32 v152, s64, v154
  v_fmac_f32 v153, s64, v155
  v_fmac_f32 v156, s64, v158
  v_fmac_f32 v157, s64, v159
  v_cvt_pk_bf16_f32 v164, v152, v153
  v_cvt_pk_bf16_f32 v165, v156, v157
  v_lshlrev_b32 v152, 16, v58
  v_and_b32 v153, 0xffff0000, v58
  v_lshlrev_b32 v154, 16, v62
  v_and_b32 v155, 0xffff0000, v62
  v_lshlrev_b32 v156, 16, v59
  v_and_b32 v157, 0xffff0000, v59
  v_lshlrev_b32 v158, 16, v63
  v_and_b32 v159, 0xffff0000, v63
  v_fmac_f32 v152, s64, v154
  v_fmac_f32 v153, s64, v155
  v_fmac_f32 v156, s64, v158
  v_fmac_f32 v157, s64, v159
  v_cvt_pk_bf16_f32 v166, v152, v153
  v_cvt_pk_bf16_f32 v167, v156, v157
  ds_write_b128 v6, v[164:167] offset:17408
  s_waitcnt vmcnt(10)
  s_xor_b32 s55, s71, 81920
  buffer_load_dwordx4 v[112:115], v4, s[8:11], s55 offen offset:0
  buffer_load_dwordx4 v[116:119], v4, s[8:11], s55 offen offset:512
  v_lshlrev_b32 v152, 16, v64
  v_and_b32 v153, 0xffff0000, v64
  v_lshlrev_b32 v154, 16, v68
  v_and_b32 v155, 0xffff0000, v68
  v_lshlrev_b32 v156, 16, v65
  v_and_b32 v157, 0xffff0000, v65
  v_lshlrev_b32 v158, 16, v69
  v_and_b32 v159, 0xffff0000, v69
  v_fmac_f32 v152, s64, v154
  v_fmac_f32 v153, s64, v155
  v_fmac_f32 v156, s64, v158
  v_fmac_f32 v157, s64, v159
  v_cvt_pk_bf16_f32 v160, v152, v153
  v_cvt_pk_bf16_f32 v161, v156, v157
  v_lshlrev_b32 v152, 16, v66
  v_and_b32 v153, 0xffff0000, v66
  v_lshlrev_b32 v154, 16, v70
  v_and_b32 v155, 0xffff0000, v70
  v_lshlrev_b32 v156, 16, v67
  v_and_b32 v157, 0xffff0000, v67
  v_lshlrev_b32 v158, 16, v71
  v_and_b32 v159, 0xffff0000, v71
  v_fmac_f32 v152, s64, v154
  v_fmac_f32 v153, s64, v155
  v_fmac_f32 v156, s64, v158
  v_fmac_f32 v157, s64, v159
  v_cvt_pk_bf16_f32 v162, v152, v153
  v_cvt_pk_bf16_f32 v163, v156, v157
  ds_write_b128 v7, v[160:163] offset:18432
  s_waitcnt vmcnt(10)
  s_xor_b32 s55, s71, 83968
  buffer_load_dwordx4 v[120:123], v4, s[8:11], s55 offen offset:0
  buffer_load_dwordx4 v[124:127], v4, s[8:11], s55 offen offset:512
  s_lshl_b32 s74, s51, 3
  s_add_u32 s74, s74, s53
  s_lshl_b32 s55, s51, 2
  s_add_u32 s55, s55, s49
  s_lshl_b32 s55, s55, 3
  s_add_u32 s55, s55, s53
  s_mul_i32 s55, s55, 4112
  s_bfe_u32 s75, s2, 0x20003
  s_lshl_b32 s56, s75, 7
  s_add_u32 s55, s55, s56
  v_lshrrev_b32 v1, 3, v0
  v_mul_u32_u24 v1, 514, v1
  v_and_b32 v2, 7, v0
  v_lshl_add_u32 v1, v2, 4, v1
  s_lshl_b32 s56, s49, 10
  s_add_u32 m0, s56, 147456
  s_nop 0
  buffer_load_dwordx4 v1, s[36:39], s55 offen nt lds
  s_add_u32 m0, s56, 151552
  s_nop 0
  buffer_load_dwordx4 v1, s[40:43], s55 offen nt lds
  buffer_load_dwordx4 v[144:147], v11, s[44:47], 0 offen offset:0
  buffer_load_dwordx4 v[148:151], v11, s[44:47], 0 offen offset:512
  v_and_b32 v1, 3, v0
  v_lshrrev_b32 v2, 2, v0
  v_lshl_add_u32 v1, v1, 6, v2
  v_mul_u32_u24 v1, 514, v1
  s_lshr_b32 s56, s73, 2
  s_lshl_b32 s56, s56, 4
  s_and_b32 s55, s73, 3
  s_add_u32 s56, s56, s55
  s_mul_i32 s56, s56, 8224
  s_lshl_b32 s55, s49, 4
  s_lshl_b64 exec, 0xffff, s55
  buffer_load_ushort v9, v1, s[36:39], s56 offen offset:512
  buffer_load_ushort v10, v1, s[40:43], s56 offen offset:512
  s_mov_b64 exec, -1
  v_lshlrev_b32 v152, 16, v72
  v_and_b32 v153, 0xffff0000, v72
  v_lshlrev_b32 v154, 16, v76
  v_and_b32 v155, 0xffff0000, v76
  v_lshlrev_b32 v156, 16, v73
  v_and_b32 v157, 0xffff0000, v73
  v_lshlrev_b32 v158, 16, v77
  v_and_b32 v159, 0xffff0000, v77
  v_fmac_f32 v152, s64, v154
  v_fmac_f32 v153, s64, v155
  v_fmac_f32 v156, s64, v158
  v_fmac_f32 v157, s64, v159
  v_cvt_pk_bf16_f32 v164, v152, v153
  v_cvt_pk_bf16_f32 v165, v156, v157
  v_lshlrev_b32 v152, 16, v74
  v_and_b32 v153, 0xffff0000, v74
  v_lshlrev_b32 v154, 16, v78
  v_and_b32 v155, 0xffff0000, v78
  v_lshlrev_b32 v156, 16, v75
  v_and_b32 v157, 0xffff0000, v75
  v_lshlrev_b32 v158, 16, v79
  v_and_b32 v159, 0xffff0000, v79
  v_fmac_f32 v152, s64, v154
  v_fmac_f32 v153, s64, v155
  v_fmac_f32 v156, s64, v158
  v_fmac_f32 v157, s64, v159
  v_cvt_pk_bf16_f32 v166, v152, v153
  v_cvt_pk_bf16_f32 v167, v156, v157
  ds_write_b128 v8, v[164:167] offset:19456
  s_waitcnt lgkmcnt(0)
  s_barrier
  s_waitcnt vmcnt(16)
  s_xor_b32 s55, s71, 86016
  buffer_load_dwordx4 v[128:131], v4, s[8:11], s55 offen offset:0
  buffer_load_dwordx4 v[132:135], v4, s[8:11], s55 offen offset:512
  v_lshlrev_b32 v152, 16, v80
  v_and_b32 v153, 0xffff0000, v80
  v_lshlrev_b32 v154, 16, v84
  v_and_b32 v155, 0xffff0000, v84
  v_lshlrev_b32 v156, 16, v81
  v_and_b32 v157, 0xffff0000, v81
  v_lshlrev_b32 v158, 16, v85
  v_and_b32 v159, 0xffff0000, v85
  v_fmac_f32 v152, s64, v154
  v_fmac_f32 v153, s64, v155
  v_fmac_f32 v156, s64, v158
  v_fmac_f32 v157, s64, v159
  v_cvt_pk_bf16_f32 v160, v152, v153
  v_cvt_pk_bf16_f32 v161, v156, v157
  v_lshlrev_b32 v152, 16, v82
  v_and_b32 v153, 0xffff0000, v82
  v_lshlrev_b32 v154, 16, v86
  v_and_b32 v155, 0xffff0000, v86
  v_lshlrev_b32 v156, 16, v83
  v_and_b32 v157, 0xffff0000, v83
  v_lshlrev_b32 v158, 16, v87
  v_and_b32 v159, 0xffff0000, v87
  v_fmac_f32 v152, s64, v154
  v_fmac_f32 v153, s64, v155
  v_fmac_f32 v156, s64, v158
  v_fmac_f32 v157, s64, v159
  v_cvt_pk_bf16_f32 v162, v152, v153
  v_cvt_pk_bf16_f32 v163, v156, v157
  ds_write_b128 v5, v[160:163] offset:32768
  s_waitcnt vmcnt(16)
  s_xor_b32 s55, s71, 88064
  buffer_load_dwordx4 v[136:139], v4, s[8:11], s55 offen offset:0
  buffer_load_dwordx4 v[140:143], v4, s[8:11], s55 offen offset:512
  v_lshlrev_b32 v152, 16, v88
  v_and_b32 v153, 0xffff0000, v88
  v_lshlrev_b32 v154, 16, v92
  v_and_b32 v155, 0xffff0000, v92
  v_lshlrev_b32 v156, 16, v89
  v_and_b32 v157, 0xffff0000, v89
  v_lshlrev_b32 v158, 16, v93
  v_and_b32 v159, 0xffff0000, v93
  v_fmac_f32 v152, s64, v154
  v_fmac_f32 v153, s64, v155
  v_fmac_f32 v156, s64, v158
  v_fmac_f32 v157, s64, v159
  v_cvt_pk_bf16_f32 v164, v152, v153
  v_cvt_pk_bf16_f32 v165, v156, v157
  v_lshlrev_b32 v152, 16, v90
  v_and_b32 v153, 0xffff0000, v90
  v_lshlrev_b32 v154, 16, v94
  v_and_b32 v155, 0xffff0000, v94
  v_lshlrev_b32 v156, 16, v91
  v_and_b32 v157, 0xffff0000, v91
  v_lshlrev_b32 v158, 16, v95
  v_and_b32 v159, 0xffff0000, v95
  v_fmac_f32 v152, s64, v154
  v_fmac_f32 v153, s64, v155
  v_fmac_f32 v156, s64, v158
  v_fmac_f32 v157, s64, v159
  v_cvt_pk_bf16_f32 v166, v152, v153
  v_cvt_pk_bf16_f32 v167, v156, v157
  ds_write_b128 v6, v[164:167] offset:33792
  s_waitcnt vmcnt(16)
  v_lshlrev_b32 v152, 16, v96
  v_and_b32 v153, 0xffff0000, v96
  v_lshlrev_b32 v154, 16, v100
  v_and_b32 v155, 0xffff0000, v100
  v_lshlrev_b32 v156, 16, v97
  v_and_b32 v157, 0xffff0000, v97
  v_lshlrev_b32 v158, 16, v101
  v_and_b32 v159, 0xffff0000, v101
  v_fmac_f32 v152, s64, v154
  v_fmac_f32 v153, s64, v155
  v_fmac_f32 v156, s64, v158
  v_fmac_f32 v157, s64, v159
  v_cvt_pk_bf16_f32 v160, v152, v153
  v_cvt_pk_bf16_f32 v161, v156, v157
  v_lshlrev_b32 v152, 16, v98
  v_and_b32 v153, 0xffff0000, v98
  v_lshlrev_b32 v154, 16, v102
  v_and_b32 v155, 0xffff0000, v102
  v_lshlrev_b32 v156, 16, v99
  v_and_b32 v157, 0xffff0000, v99
  v_lshlrev_b32 v158, 16, v103
  v_and_b32 v159, 0xffff0000, v103
  v_fmac_f32 v152, s64, v154
  v_fmac_f32 v153, s64, v155
  v_fmac_f32 v156, s64, v158
  v_fmac_f32 v157, s64, v159
  v_cvt_pk_bf16_f32 v162, v152, v153
  v_cvt_pk_bf16_f32 v163, v156, v157
  ds_write_b128 v7, v[160:163] offset:34816
  s_waitcnt vmcnt(14)
  v_lshlrev_b32 v152, 16, v104
  v_and_b32 v153, 0xffff0000, v104
  v_lshlrev_b32 v154, 16, v108
  v_and_b32 v155, 0xffff0000, v108
  v_lshlrev_b32 v156, 16, v105
  v_and_b32 v157, 0xffff0000, v105
  v_lshlrev_b32 v158, 16, v109
  v_and_b32 v159, 0xffff0000, v109
  v_fmac_f32 v152, s64, v154
  v_fmac_f32 v153, s64, v155
  v_fmac_f32 v156, s64, v158
  v_fmac_f32 v157, s64, v159
  v_cvt_pk_bf16_f32 v164, v152, v153
  v_cvt_pk_bf16_f32 v165, v156, v157
  v_lshlrev_b32 v152, 16, v106
  v_and_b32 v153, 0xffff0000, v106
  v_lshlrev_b32 v154, 16, v110
  v_and_b32 v155, 0xffff0000, v110
  v_lshlrev_b32 v156, 16, v107
  v_and_b32 v157, 0xffff0000, v107
  v_lshlrev_b32 v158, 16, v111
  v_and_b32 v159, 0xffff0000, v111
  v_fmac_f32 v152, s64, v154
  v_fmac_f32 v153, s64, v155
  v_fmac_f32 v156, s64, v158
  v_fmac_f32 v157, s64, v159
  v_cvt_pk_bf16_f32 v166, v152, v153
  v_cvt_pk_bf16_f32 v167, v156, v157
  ds_write_b128 v8, v[164:167] offset:35840
  s_waitcnt lgkmcnt(0)
  s_barrier
  s_waitcnt vmcnt(12)
  s_cmp_lg_u32 s49, 0
  s_cselect_b32 s55, 0x1000, 0
  v_lshl_add_u32 v187, v0, 8, s55
  buffer_load_dword v188, v187, s[32:35], 0 offen sc1
  v_lshlrev_b32 v152, 16, v112
  v_and_b32 v153, 0xffff0000, v112
  v_lshlrev_b32 v154, 16, v116
  v_and_b32 v155, 0xffff0000, v116
  v_lshlrev_b32 v156, 16, v113
  v_and_b32 v157, 0xffff0000, v113
  v_lshlrev_b32 v158, 16, v117
  v_and_b32 v159, 0xffff0000, v117
  v_fmac_f32 v152, s64, v154
  v_fmac_f32 v153, s64, v155
  v_fmac_f32 v156, s64, v158
  v_fmac_f32 v157, s64, v159
  v_cvt_pk_bf16_f32 v160, v152, v153
  v_cvt_pk_bf16_f32 v161, v156, v157
  v_lshlrev_b32 v152, 16, v114
  v_and_b32 v153, 0xffff0000, v114
  v_lshlrev_b32 v154, 16, v118
  v_and_b32 v155, 0xffff0000, v118
  v_lshlrev_b32 v156, 16, v115
  v_and_b32 v157, 0xffff0000, v115
  v_lshlrev_b32 v158, 16, v119
  v_and_b32 v159, 0xffff0000, v119
  v_fmac_f32 v152, s64, v154
  v_fmac_f32 v153, s64, v155
  v_fmac_f32 v156, s64, v158
  v_fmac_f32 v157, s64, v159
  v_cvt_pk_bf16_f32 v162, v152, v153
  v_cvt_pk_bf16_f32 v163, v156, v157
  ds_write_b128 v5, v[160:163] offset:49152
  s_waitcnt vmcnt(11)
  v_lshlrev_b32 v152, 16, v120
  v_and_b32 v153, 0xffff0000, v120
  v_lshlrev_b32 v154, 16, v124
  v_and_b32 v155, 0xffff0000, v124
  v_lshlrev_b32 v156, 16, v121
  v_and_b32 v157, 0xffff0000, v121
  v_lshlrev_b32 v158, 16, v125
  v_and_b32 v159, 0xffff0000, v125
  v_fmac_f32 v152, s64, v154
  v_fmac_f32 v153, s64, v155
  v_fmac_f32 v156, s64, v158
  v_fmac_f32 v157, s64, v159
  v_cvt_pk_bf16_f32 v164, v152, v153
  v_cvt_pk_bf16_f32 v165, v156, v157
  v_lshlrev_b32 v152, 16, v122
  v_and_b32 v153, 0xffff0000, v122
  v_lshlrev_b32 v154, 16, v126
  v_and_b32 v155, 0xffff0000, v126
  v_lshlrev_b32 v156, 16, v123
  v_and_b32 v157, 0xffff0000, v123
  v_lshlrev_b32 v158, 16, v127
  v_and_b32 v159, 0xffff0000, v127
  v_fmac_f32 v152, s64, v154
  v_fmac_f32 v153, s64, v155
  v_fmac_f32 v156, s64, v158
  v_fmac_f32 v157, s64, v159
  v_cvt_pk_bf16_f32 v166, v152, v153
  v_cvt_pk_bf16_f32 v167, v156, v157
  ds_write_b128 v6, v[164:167] offset:50176
  s_waitcnt vmcnt(3)
  v_lshlrev_b32 v152, 16, v128
  v_and_b32 v153, 0xffff0000, v128
  v_lshlrev_b32 v154, 16, v132
  v_and_b32 v155, 0xffff0000, v132
  v_lshlrev_b32 v156, 16, v129
  v_and_b32 v157, 0xffff0000, v129
  v_lshlrev_b32 v158, 16, v133
  v_and_b32 v159, 0xffff0000, v133
  v_fmac_f32 v152, s64, v154
  v_fmac_f32 v153, s64, v155
  v_fmac_f32 v156, s64, v158
  v_fmac_f32 v157, s64, v159
  v_cvt_pk_bf16_f32 v160, v152, v153
  v_cvt_pk_bf16_f32 v161, v156, v157
  v_lshlrev_b32 v152, 16, v130
  v_and_b32 v153, 0xffff0000, v130
  v_lshlrev_b32 v154, 16, v134
  v_and_b32 v155, 0xffff0000, v134
  v_lshlrev_b32 v156, 16, v131
  v_and_b32 v157, 0xffff0000, v131
  v_lshlrev_b32 v158, 16, v135
  v_and_b32 v159, 0xffff0000, v135
  v_fmac_f32 v152, s64, v154
  v_fmac_f32 v153, s64, v155
  v_fmac_f32 v156, s64, v158
  v_fmac_f32 v157, s64, v159
  v_cvt_pk_bf16_f32 v162, v152, v153
  v_cvt_pk_bf16_f32 v163, v156, v157
  ds_write_b128 v7, v[160:163] offset:51200
  s_waitcnt vmcnt(1)
  v_lshlrev_b32 v152, 16, v136
  v_and_b32 v153, 0xffff0000, v136
  v_lshlrev_b32 v154, 16, v140
  v_and_b32 v155, 0xffff0000, v140
  v_lshlrev_b32 v156, 16, v137
  v_and_b32 v157, 0xffff0000, v137
  v_lshlrev_b32 v158, 16, v141
  v_and_b32 v159, 0xffff0000, v141
  v_fmac_f32 v152, s64, v154
  v_fmac_f32 v153, s64, v155
  v_fmac_f32 v156, s64, v158
  v_fmac_f32 v157, s64, v159
  v_cvt_pk_bf16_f32 v164, v152, v153
  v_cvt_pk_bf16_f32 v165, v156, v157
  v_lshlrev_b32 v152, 16, v138
  v_and_b32 v153, 0xffff0000, v138
  v_lshlrev_b32 v154, 16, v142
  v_and_b32 v155, 0xffff0000, v142
  v_lshlrev_b32 v156, 16, v139
  v_and_b32 v157, 0xffff0000, v139
  v_lshlrev_b32 v158, 16, v143
  v_and_b32 v159, 0xffff0000, v143
  v_fmac_f32 v152, s64, v154
  v_fmac_f32 v153, s64, v155
  v_fmac_f32 v156, s64, v158
  v_fmac_f32 v157, s64, v159
  v_cvt_pk_bf16_f32 v166, v152, v153
  v_cvt_pk_bf16_f32 v167, v156, v157
  ds_write_b128 v8, v[164:167] offset:52224
  s_cmp_lg_u32 s49, 0
  s_cbranch_scc1 L_ini3
  s_waitcnt vmcnt(0)
  s_mov_b32 exec_lo, 0x1
  s_mov_b32 exec_hi, 0x0
  s_mov_b32 s63, 0x80000
  v_cmp_gt_u32 vcc, 7, v188
  s_nop 0
  s_cbranch_vccz PX23
P23:
  buffer_load_dword v1, v187, s[32:35], 0 offen sc1
  s_sub_u32 s63, s63, 1
  s_cbranch_scc1 PX23
  s_waitcnt vmcnt(0)
  v_cmp_gt_u32 vcc, 7, v1
  s_nop 0
  s_cbranch_vccz PX23
  s_mov_b64 exec, vcc
  s_sleep 2
  s_branch P23
PX23:
  s_mov_b64 exec, -1
L_ini3:
  s_waitcnt lgkmcnt(0)
  s_barrier
  v_mov_b32 v2, s82
  v_mov_b32 v1, 1
  s_mov_b64 exec, 1
  ds_add_u32 v2, v1 offset:16
  s_mov_b64 exec, -1
  v_mov_b32 v2, s82
  s_mov_b32 s63, 0x800000
  s_mov_b64 exec, 1
W24:
  ds_read_b32 v1, v2 offset:16
  s_sub_u32 s63, s63, 1
  s_cbranch_scc1 WX24
  s_waitcnt lgkmcnt(0)
  v_cmp_gt_u32 vcc, 4, v1
  s_nop 0
  s_cbranch_vccnz W24
WX24:
  s_mov_b64 exec, -1
  v_and_b32 v1, 7, v0
  v_lshrrev_b32 v2, 3, v0
  v_lshlrev_b32 v208, 7, v1
  v_lshl_add_u32 v208, v2, 4, v208
  s_lshl_b32 s55, s49, 2
  s_add_u32 s55, s55, 147456
  v_add_u32 v208, s55, v208
  ds_read_b32 v192, v208 offset:0
  ds_read_b32 v193, v208 offset:1024
  ds_read_b32 v194, v208 offset:2048
  ds_read_b32 v195, v208 offset:3072
  ds_read_b32 v196, v208 offset:4096
  ds_read_b32 v197, v208 offset:5120
  ds_read_b32 v198, v208 offset:6144
  ds_read_b32 v199, v208 offset:7168
  v_mul_u32_u24 v2, 67584, v2
  v_lshl_add_u32 v1, v1, 4, v2
  s_lshl_b32 s55, s75, 5
  s_add_u32 s55, s55, s49
  s_mul_i32 s55, s55, 16896
  s_lshl_b32 s56, s74, 7
  s_add_u32 s55, s55, s56
  s_add_u32 s55, s55, 11534336
  s_add_u32 s56, s55, 8448
  s_mov_b32 s76, 0x05040100
  s_mov_b32 s77, 0x07060302
  s_waitcnt lgkmcnt(0)
  v_perm_b32 v200, v196, v192, s76
  v_perm_b32 v201, v197, v193, s76
  v_perm_b32 v202, v198, v194, s76
  v_perm_b32 v203, v199, v195, s76
  v_perm_b32 v204, v196, v192, s77
  v_perm_b32 v205, v197, v193, s77
  v_perm_b32 v206, v198, v194, s77
  v_perm_b32 v207, v199, v195, s77
  buffer_store_dwordx4 v[200:203], v1, s[20:23], s55 offen sc1
  buffer_store_dwordx4 v[204:207], v1, s[20:23], s56 offen sc1
  v_lshl_or_b32 v2, v10, 16, v9
  v_lshlrev_b32 v1, 2, v0
  s_lshl_b32 s56, s73, 8
  s_add_u32 s56, s56, 13697024
  s_lshl_b32 s55, s49, 4
  s_lshl_b64 exec, 0xffff, s55
  buffer_store_dword v2, v1, s[20:23], s56 offen sc1
  s_mov_b64 exec, -1
  v_and_b32 v212, 0xffff0000, v144
  v_and_b32 v144, 0xffff, v144
  v_and_b32 v213, 0xffff0000, v145
  v_and_b32 v145, 0xffff, v145
  v_and_b32 v214, 0xffff0000, v146
  v_and_b32 v146, 0xffff, v146
  v_and_b32 v215, 0xffff0000, v147
  v_and_b32 v147, 0xffff, v147
  v_and_b32 v216, 0xffff0000, v148
  v_and_b32 v148, 0xffff, v148
  v_and_b32 v217, 0xffff0000, v149
  v_and_b32 v149, 0xffff, v149
  v_and_b32 v218, 0xffff0000, v150
  v_and_b32 v150, 0xffff, v150
  v_and_b32 v219, 0xffff0000, v151
  v_and_b32 v151, 0xffff, v151
  s_mov_b32 s55, 0x3f803f80
  v_dot2_f32_bf16 v220, v16, v144, 0
  v_dot2_f32_bf16 v221, v16, v212, 0
  v_dot2_f32_bf16 v222, v24, v144, 0
  v_dot2_f32_bf16 v223, v24, v212, 0
  v_dot2_f32_bf16 v224, v32, v144, 0
  v_dot2_f32_bf16 v225, v32, v212, 0
  v_dot2_f32_bf16 v226, v40, v144, 0
  v_dot2_f32_bf16 v227, v40, v212, 0
  v_dot2_f32_bf16 v228, v48, v144, 0
  v_dot2_f32_bf16 v229, v48, v212, 0
  v_dot2_f32_bf16 v230, v56, v144, 0
  v_dot2_f32_bf16 v231, v56, v212, 0
  v_dot2_f32_bf16 v232, v64, v144, 0
  v_dot2_f32_bf16 v233, v64, v212, 0
  v_dot2_f32_bf16 v234, v72, v144, 0
  v_dot2_f32_bf16 v235, v72, v212, 0
  v_cvt_pk_bf16_f32 v236, v220, v221
  v_cvt_pk_bf16_f32 v237, v222, v223
  v_cvt_pk_bf16_f32 v238, v224, v225
  v_cvt_pk_bf16_f32 v239, v226, v227
  v_cvt_pk_bf16_f32 v240, v228, v229
  v_cvt_pk_bf16_f32 v241, v230, v231
  v_cvt_pk_bf16_f32 v242, v232, v233
  v_cvt_pk_bf16_f32 v243, v234, v235
  v_dot2_f32_bf16 v168, v236, s55, 0
  v_dot2_f32_bf16 v169, v237, s55, 0
  v_dot2_f32_bf16 v170, v238, s55, 0
  v_dot2_f32_bf16 v171, v239, s55, 0
  v_dot2_f32_bf16 v172, v240, s55, 0
  v_dot2_f32_bf16 v173, v241, s55, 0
  v_dot2_f32_bf16 v174, v242, s55, 0
  v_dot2_f32_bf16 v175, v243, s55, 0
  v_dot2_f32_bf16 v220, v17, v145, 0
  v_dot2_f32_bf16 v221, v17, v213, 0
  v_dot2_f32_bf16 v222, v25, v145, 0
  v_dot2_f32_bf16 v223, v25, v213, 0
  v_dot2_f32_bf16 v224, v33, v145, 0
  v_dot2_f32_bf16 v225, v33, v213, 0
  v_dot2_f32_bf16 v226, v41, v145, 0
  v_dot2_f32_bf16 v227, v41, v213, 0
  v_dot2_f32_bf16 v228, v49, v145, 0
  v_dot2_f32_bf16 v229, v49, v213, 0
  v_dot2_f32_bf16 v230, v57, v145, 0
  v_dot2_f32_bf16 v231, v57, v213, 0
  v_dot2_f32_bf16 v232, v65, v145, 0
  v_dot2_f32_bf16 v233, v65, v213, 0
  v_dot2_f32_bf16 v234, v73, v145, 0
  v_dot2_f32_bf16 v235, v73, v213, 0
  v_cvt_pk_bf16_f32 v236, v220, v221
  v_cvt_pk_bf16_f32 v237, v222, v223
  v_cvt_pk_bf16_f32 v238, v224, v225
  v_cvt_pk_bf16_f32 v239, v226, v227
  v_cvt_pk_bf16_f32 v240, v228, v229
  v_cvt_pk_bf16_f32 v241, v230, v231
  v_cvt_pk_bf16_f32 v242, v232, v233
  v_cvt_pk_bf16_f32 v243, v234, v235
  v_dot2_f32_bf16 v168, v236, s55, v168
  v_dot2_f32_bf16 v169, v237, s55, v169
  v_dot2_f32_bf16 v170, v238, s55, v170
  v_dot2_f32_bf16 v171, v239, s55, v171
  v_dot2_f32_bf16 v172, v240, s55, v172
  v_dot2_f32_bf16 v173, v241, s55, v173
  v_dot2_f32_bf16 v174, v242, s55, v174
  v_dot2_f32_bf16 v175, v243, s55, v175
  v_dot2_f32_bf16 v220, v18, v146, 0
  v_dot2_f32_bf16 v221, v18, v214, 0
  v_dot2_f32_bf16 v222, v26, v146, 0
  v_dot2_f32_bf16 v223, v26, v214, 0
  v_dot2_f32_bf16 v224, v34, v146, 0
  v_dot2_f32_bf16 v225, v34, v214, 0
  v_dot2_f32_bf16 v226, v42, v146, 0
  v_dot2_f32_bf16 v227, v42, v214, 0
  v_dot2_f32_bf16 v228, v50, v146, 0
  v_dot2_f32_bf16 v229, v50, v214, 0
  v_dot2_f32_bf16 v230, v58, v146, 0
  v_dot2_f32_bf16 v231, v58, v214, 0
  v_dot2_f32_bf16 v232, v66, v146, 0
  v_dot2_f32_bf16 v233, v66, v214, 0
  v_dot2_f32_bf16 v234, v74, v146, 0
  v_dot2_f32_bf16 v235, v74, v214, 0
  v_cvt_pk_bf16_f32 v236, v220, v221
  v_cvt_pk_bf16_f32 v237, v222, v223
  v_cvt_pk_bf16_f32 v238, v224, v225
  v_cvt_pk_bf16_f32 v239, v226, v227
  v_cvt_pk_bf16_f32 v240, v228, v229
  v_cvt_pk_bf16_f32 v241, v230, v231
  v_cvt_pk_bf16_f32 v242, v232, v233
  v_cvt_pk_bf16_f32 v243, v234, v235
  v_dot2_f32_bf16 v168, v236, s55, v168
  v_dot2_f32_bf16 v169, v237, s55, v169
  v_dot2_f32_bf16 v170, v238, s55, v170
  v_dot2_f32_bf16 v171, v239, s55, v171
  v_dot2_f32_bf16 v172, v240, s55, v172
  v_dot2_f32_bf16 v173, v241, s55, v173
  v_dot2_f32_bf16 v174, v242, s55, v174
  v_dot2_f32_bf16 v175, v243, s55, v175
  v_dot2_f32_bf16 v220, v19, v147, 0
  v_dot2_f32_bf16 v221, v19, v215, 0
  v_dot2_f32_bf16 v222, v27, v147, 0
  v_dot2_f32_bf16 v223, v27, v215, 0
  v_dot2_f32_bf16 v224, v35, v147, 0
  v_dot2_f32_bf16 v225, v35, v215, 0
  v_dot2_f32_bf16 v226, v43, v147, 0
  v_dot2_f32_bf16 v227, v43, v215, 0
  v_dot2_f32_bf16 v228, v51, v147, 0
  v_dot2_f32_bf16 v229, v51, v215, 0
  v_dot2_f32_bf16 v230, v59, v147, 0
  v_dot2_f32_bf16 v231, v59, v215, 0
  v_dot2_f32_bf16 v232, v67, v147, 0
  v_dot2_f32_bf16 v233, v67, v215, 0
  v_dot2_f32_bf16 v234, v75, v147, 0
  v_dot2_f32_bf16 v235, v75, v215, 0
  v_cvt_pk_bf16_f32 v236, v220, v221
  v_cvt_pk_bf16_f32 v237, v222, v223
  v_cvt_pk_bf16_f32 v238, v224, v225
  v_cvt_pk_bf16_f32 v239, v226, v227
  v_cvt_pk_bf16_f32 v240, v228, v229
  v_cvt_pk_bf16_f32 v241, v230, v231
  v_cvt_pk_bf16_f32 v242, v232, v233
  v_cvt_pk_bf16_f32 v243, v234, v235
  v_dot2_f32_bf16 v168, v236, s55, v168
  v_dot2_f32_bf16 v169, v237, s55, v169
  v_dot2_f32_bf16 v170, v238, s55, v170
  v_dot2_f32_bf16 v171, v239, s55, v171
  v_dot2_f32_bf16 v172, v240, s55, v172
  v_dot2_f32_bf16 v173, v241, s55, v173
  v_dot2_f32_bf16 v174, v242, s55, v174
  v_dot2_f32_bf16 v175, v243, s55, v175
  v_dot2_f32_bf16 v220, v20, v148, 0
  v_dot2_f32_bf16 v221, v20, v216, 0
  v_dot2_f32_bf16 v222, v28, v148, 0
  v_dot2_f32_bf16 v223, v28, v216, 0
  v_dot2_f32_bf16 v224, v36, v148, 0
  v_dot2_f32_bf16 v225, v36, v216, 0
  v_dot2_f32_bf16 v226, v44, v148, 0
  v_dot2_f32_bf16 v227, v44, v216, 0
  v_dot2_f32_bf16 v228, v52, v148, 0
  v_dot2_f32_bf16 v229, v52, v216, 0
  v_dot2_f32_bf16 v230, v60, v148, 0
  v_dot2_f32_bf16 v231, v60, v216, 0
  v_dot2_f32_bf16 v232, v68, v148, 0
  v_dot2_f32_bf16 v233, v68, v216, 0
  v_dot2_f32_bf16 v234, v76, v148, 0
  v_dot2_f32_bf16 v235, v76, v216, 0
  v_cvt_pk_bf16_f32 v236, v220, v221
  v_cvt_pk_bf16_f32 v237, v222, v223
  v_cvt_pk_bf16_f32 v238, v224, v225
  v_cvt_pk_bf16_f32 v239, v226, v227
  v_cvt_pk_bf16_f32 v240, v228, v229
  v_cvt_pk_bf16_f32 v241, v230, v231
  v_cvt_pk_bf16_f32 v242, v232, v233
  v_cvt_pk_bf16_f32 v243, v234, v235
  v_dot2_f32_bf16 v168, v236, s55, v168
  v_dot2_f32_bf16 v169, v237, s55, v169
  v_dot2_f32_bf16 v170, v238, s55, v170
  v_dot2_f32_bf16 v171, v239, s55, v171
  v_dot2_f32_bf16 v172, v240, s55, v172
  v_dot2_f32_bf16 v173, v241, s55, v173
  v_dot2_f32_bf16 v174, v242, s55, v174
  v_dot2_f32_bf16 v175, v243, s55, v175
  v_dot2_f32_bf16 v220, v21, v149, 0
  v_dot2_f32_bf16 v221, v21, v217, 0
  v_dot2_f32_bf16 v222, v29, v149, 0
  v_dot2_f32_bf16 v223, v29, v217, 0
  v_dot2_f32_bf16 v224, v37, v149, 0
  v_dot2_f32_bf16 v225, v37, v217, 0
  v_dot2_f32_bf16 v226, v45, v149, 0
  v_dot2_f32_bf16 v227, v45, v217, 0
  v_dot2_f32_bf16 v228, v53, v149, 0
  v_dot2_f32_bf16 v229, v53, v217, 0
  v_dot2_f32_bf16 v230, v61, v149, 0
  v_dot2_f32_bf16 v231, v61, v217, 0
  v_dot2_f32_bf16 v232, v69, v149, 0
  v_dot2_f32_bf16 v233, v69, v217, 0
  v_dot2_f32_bf16 v234, v77, v149, 0
  v_dot2_f32_bf16 v235, v77, v217, 0
  v_cvt_pk_bf16_f32 v236, v220, v221
  v_cvt_pk_bf16_f32 v237, v222, v223
  v_cvt_pk_bf16_f32 v238, v224, v225
  v_cvt_pk_bf16_f32 v239, v226, v227
  v_cvt_pk_bf16_f32 v240, v228, v229
  v_cvt_pk_bf16_f32 v241, v230, v231
  v_cvt_pk_bf16_f32 v242, v232, v233
  v_cvt_pk_bf16_f32 v243, v234, v235
  v_dot2_f32_bf16 v168, v236, s55, v168
  v_dot2_f32_bf16 v169, v237, s55, v169
  v_dot2_f32_bf16 v170, v238, s55, v170
  v_dot2_f32_bf16 v171, v239, s55, v171
  v_dot2_f32_bf16 v172, v240, s55, v172
  v_dot2_f32_bf16 v173, v241, s55, v173
  v_dot2_f32_bf16 v174, v242, s55, v174
  v_dot2_f32_bf16 v175, v243, s55, v175
  v_dot2_f32_bf16 v220, v22, v150, 0
  v_dot2_f32_bf16 v221, v22, v218, 0
  v_dot2_f32_bf16 v222, v30, v150, 0
  v_dot2_f32_bf16 v223, v30, v218, 0
  v_dot2_f32_bf16 v224, v38, v150, 0
  v_dot2_f32_bf16 v225, v38, v218, 0
  v_dot2_f32_bf16 v226, v46, v150, 0
  v_dot2_f32_bf16 v227, v46, v218, 0
  v_dot2_f32_bf16 v228, v54, v150, 0
  v_dot2_f32_bf16 v229, v54, v218, 0
  v_dot2_f32_bf16 v230, v62, v150, 0
  v_dot2_f32_bf16 v231, v62, v218, 0
  v_dot2_f32_bf16 v232, v70, v150, 0
  v_dot2_f32_bf16 v233, v70, v218, 0
  v_dot2_f32_bf16 v234, v78, v150, 0
  v_dot2_f32_bf16 v235, v78, v218, 0
  v_cvt_pk_bf16_f32 v236, v220, v221
  v_cvt_pk_bf16_f32 v237, v222, v223
  v_cvt_pk_bf16_f32 v238, v224, v225
  v_cvt_pk_bf16_f32 v239, v226, v227
  v_cvt_pk_bf16_f32 v240, v228, v229
  v_cvt_pk_bf16_f32 v241, v230, v231
  v_cvt_pk_bf16_f32 v242, v232, v233
  v_cvt_pk_bf16_f32 v243, v234, v235
  v_dot2_f32_bf16 v168, v236, s55, v168
  v_dot2_f32_bf16 v169, v237, s55, v169
  v_dot2_f32_bf16 v170, v238, s55, v170
  v_dot2_f32_bf16 v171, v239, s55, v171
  v_dot2_f32_bf16 v172, v240, s55, v172
  v_dot2_f32_bf16 v173, v241, s55, v173
  v_dot2_f32_bf16 v174, v242, s55, v174
  v_dot2_f32_bf16 v175, v243, s55, v175
  v_dot2_f32_bf16 v220, v23, v151, 0
  v_dot2_f32_bf16 v221, v23, v219, 0
  v_dot2_f32_bf16 v222, v31, v151, 0
  v_dot2_f32_bf16 v223, v31, v219, 0
  v_dot2_f32_bf16 v224, v39, v151, 0
  v_dot2_f32_bf16 v225, v39, v219, 0
  v_dot2_f32_bf16 v226, v47, v151, 0
  v_dot2_f32_bf16 v227, v47, v219, 0
  v_dot2_f32_bf16 v228, v55, v151, 0
  v_dot2_f32_bf16 v229, v55, v219, 0
  v_dot2_f32_bf16 v230, v63, v151, 0
  v_dot2_f32_bf16 v231, v63, v219, 0
  v_dot2_f32_bf16 v232, v71, v151, 0
  v_dot2_f32_bf16 v233, v71, v219, 0
  v_dot2_f32_bf16 v234, v79, v151, 0
  v_dot2_f32_bf16 v235, v79, v219, 0
  v_cvt_pk_bf16_f32 v236, v220, v221
  v_cvt_pk_bf16_f32 v237, v222, v223
  v_cvt_pk_bf16_f32 v238, v224, v225
  v_cvt_pk_bf16_f32 v239, v226, v227
  v_cvt_pk_bf16_f32 v240, v228, v229
  v_cvt_pk_bf16_f32 v241, v230, v231
  v_cvt_pk_bf16_f32 v242, v232, v233
  v_cvt_pk_bf16_f32 v243, v234, v235
  v_dot2_f32_bf16 v168, v236, s55, v168
  v_dot2_f32_bf16 v169, v237, s55, v169
  v_dot2_f32_bf16 v170, v238, s55, v170
  v_dot2_f32_bf16 v171, v239, s55, v171
  v_dot2_f32_bf16 v172, v240, s55, v172
  v_dot2_f32_bf16 v173, v241, s55, v173
  v_dot2_f32_bf16 v174, v242, s55, v174
  v_dot2_f32_bf16 v175, v243, s55, v175
  s_waitcnt vmcnt(0)
  v_mov_b32 v2, s82
  v_mov_b32 v1, 1
  s_mov_b64 exec, 1
  ds_add_rtn_u32 v1, v2, v1 offset:24
  s_waitcnt lgkmcnt(0)
  v_cmp_ne_u32 vcc, 3, v1
  s_mov_b64 exec, -1
  s_cbranch_vccnz LS25
  s_lshl_b32 s55, s75, 10
  s_add_u32 s55, s55, 32768
  s_atomic_add s81, s[6:7], s55
  s_atomic_add s81, s[6:7], s55 offset:0x100
  s_atomic_add s81, s[6:7], s55 offset:0x200
  s_atomic_add s81, s[6:7], s55 offset:0x300
  s_atomic_add s81, s[6:7], 0x9000
LS25:
  s_setprio 2
  s_mov_b32 s55, 0x3f803f80
  v_permlane16_swap_b32 v168, v169
  v_permlane16_swap_b32 v170, v171
  v_permlane16_swap_b32 v172, v173
  v_permlane16_swap_b32 v174, v175
  v_add_f32 v168, v168, v169
  v_add_f32 v170, v170, v171
  v_add_f32 v172, v172, v173
  v_add_f32 v174, v174, v175
  v_add_f32_dpp v168, v168, v168 row_ror:8 row_mask:0xf bank_mask:0xf
  v_add_f32_dpp v170, v170, v170 row_ror:8 row_mask:0xf bank_mask:0xf
  v_add_f32_dpp v172, v172, v172 row_ror:8 row_mask:0xf bank_mask:0xf
  v_add_f32_dpp v174, v174, v174 row_ror:8 row_mask:0xf bank_mask:0xf
  v_add_f32_dpp v168, v168, v168 row_ror:4 row_mask:0xf bank_mask:0xf
  v_add_f32_dpp v170, v170, v170 row_ror:4 row_mask:0xf bank_mask:0xf
  v_add_f32_dpp v172, v172, v172 row_ror:4 row_mask:0xf bank_mask:0xf
  v_add_f32_dpp v174, v174, v174 row_ror:4 row_mask:0xf bank_mask:0xf
  v_add_f32_dpp v168, v168, v168 row_ror:2 row_mask:0xf bank_mask:0xf
  v_add_f32_dpp v170, v170, v170 row_ror:2 row_mask:0xf bank_mask:0xf
  v_add_f32_dpp v172, v172, v172 row_ror:2 row_mask:0xf bank_mask:0xf
  v_add_f32_dpp v174, v174, v174 row_ror:2 row_mask:0xf bank_mask:0xf
  v_add_f32_dpp v168, v168, v168 row_ror:1 row_mask:0xf bank_mask:0xf
  v_add_f32_dpp v170, v170, v170 row_ror:1 row_mask:0xf bank_mask:0xf
  v_add_f32_dpp v172, v172, v172 row_ror:1 row_mask:0xf bank_mask:0xf
  v_add_f32_dpp v174, v174, v174 row_ror:1 row_mask:0xf bank_mask:0xf
  v_and_b32 v1, 1, v0
  v_cmp_eq_u32 vcc, 1, v1
  v_lshlrev_b32 v1, 2, v1
  v_and_b32 v2, 2, v0
  v_cndmask_b32 v168, v168, v170, vcc
  v_cndmask_b32 v172, v172, v174, vcc
  v_cmp_eq_u32 vcc, 2, v2
  v_lshl_add_u32 v1, v2, 5, v1
  v_bfe_u32 v2, v0, 4, 1
  v_cndmask_b32 v168, v168, v172, vcc
  v_cvt_pk_bf16_f32 v168, 0, v168
  v_mul_f32 v168, 0xbfb8aa3b, v168
  v_exp_f32 v168, v168
  v_lshl_add_u32 v1, v2, 1, v1
  v_add_f32 v168, 1.0, v168
  v_rcp_f32 v168, v168
  v_lshrrev_b32 v2, 5, v0
  v_add_lshl_u32 v1, v1, v2, 2
  v_cvt_pk_bf16_f32 v168, 0, v168
  s_lshl_b32 s55, s52, 1
  s_add_u32 s55, s55, s78
  s_lshl_b32 s55, s55, 5
  s_add_u32 s55, s55, 17825792
  s_mov_b32 exec_lo, 0xf000f
  s_mov_b32 exec_hi, 0xf000f
  buffer_store_dword v168, v1, s[20:23], s55 offen sc1
  s_mov_b64 exec, -1
  v_mov_b32 v2, s82
  s_mov_b32 s63, 0x800000
  s_mov_b64 exec, 1
W26:
  ds_read_b32 v1, v2 offset:24
  s_sub_u32 s63, s63, 1
  s_cbranch_scc1 WX26
  s_waitcnt lgkmcnt(0)
  v_cmp_gt_u32 vcc, 4, v1
  s_nop 0
  s_cbranch_vccnz W26
WX26:
  s_mov_b64 exec, -1
  s_lshl_b32 s55, s49, 8
  s_add_u32 s55, s55, s79
  s_cmp_ge_u32 s55, 8
  s_cbranch_scc1 L_nocp2
  s_getpc_b64 s[4:5]
L_pc2:
  v_lshlrev_b32 v1, 7, v0
  v_min_u32 v1, L_end-L_pc2+1536, v1
  global_load_dword v190, v1, s[4:5]
L_nocp2:
  v_and_b32 v12, 15, v0
  v_lshrrev_b32 v13, 4, v0
  s_lshl_b32 s89, s49, 4
  v_add_u32 v248, s89, v12
  v_cvt_f32_u32 v248, v248
  v_mul_f32 v232, 0x3c800000, v248
  v_mul_f32 v233, 0x3a000000, v248
  v_cvt_f32_u32 v249, v13
  v_mul_f32 v249, 4.0, v249
  v_mul_f32 v234, v249, v232
  v_mul_f32 v235, v249, v233
  v_fmamk_f32 v236, v232, 0x00000000, v234
  v_cos_f32 v237, v236
  v_sin_f32 v238, v236
  v_fmamk_f32 v239, v232, 0x3f800000, v234
  v_cos_f32 v240, v239
  v_sin_f32 v241, v239
  v_cvt_pk_bf16_f32 v80, v237, v238
  v_cvt_pk_bf16_f32 v96, -v238, v237
  v_fmamk_f32 v236, v232, 0x40000000, v234
  v_cos_f32 v237, v236
  v_sin_f32 v238, v236
  v_cvt_pk_bf16_f32 v81, v240, v241
  v_cvt_pk_bf16_f32 v97, -v241, v240
  v_fmamk_f32 v239, v232, 0x40400000, v234
  v_cos_f32 v240, v239
  v_sin_f32 v241, v239
  v_cvt_pk_bf16_f32 v82, v237, v238
  v_cvt_pk_bf16_f32 v98, -v238, v237
  v_fmamk_f32 v236, v232, 0x41800000, v234
  v_cos_f32 v237, v236
  v_sin_f32 v238, v236
  v_cvt_pk_bf16_f32 v83, v240, v241
  v_cvt_pk_bf16_f32 v99, -v241, v240
  v_fmamk_f32 v239, v232, 0x41880000, v234
  v_cos_f32 v240, v239
  v_sin_f32 v241, v239
  v_cvt_pk_bf16_f32 v84, v237, v238
  v_cvt_pk_bf16_f32 v100, -v238, v237
  v_fmamk_f32 v236, v232, 0x41900000, v234
  v_cos_f32 v237, v236
  v_sin_f32 v238, v236
  v_cvt_pk_bf16_f32 v85, v240, v241
  v_cvt_pk_bf16_f32 v101, -v241, v240
  v_fmamk_f32 v239, v232, 0x41980000, v234
  v_cos_f32 v240, v239
  v_sin_f32 v241, v239
  v_cvt_pk_bf16_f32 v86, v237, v238
  v_cvt_pk_bf16_f32 v102, -v238, v237
  v_fmamk_f32 v236, v232, 0x42000000, v234
  v_cos_f32 v237, v236
  v_sin_f32 v238, v236
  v_cvt_pk_bf16_f32 v87, v240, v241
  v_cvt_pk_bf16_f32 v103, -v241, v240
  v_fmamk_f32 v239, v232, 0x42040000, v234
  v_cos_f32 v240, v239
  v_sin_f32 v241, v239
  v_cvt_pk_bf16_f32 v88, v237, v238
  v_cvt_pk_bf16_f32 v104, -v238, v237
  v_fmamk_f32 v236, v232, 0x42080000, v234
  v_cos_f32 v237, v236
  v_sin_f32 v238, v236
  v_cvt_pk_bf16_f32 v89, v240, v241
  v_cvt_pk_bf16_f32 v105, -v241, v240
  v_fmamk_f32 v239, v232, 0x420c0000, v234
  v_cos_f32 v240, v239
  v_sin_f32 v241, v239
  v_cvt_pk_bf16_f32 v90, v237, v238
  v_cvt_pk_bf16_f32 v106, -v238, v237
  v_fmamk_f32 v236, v232, 0x42400000, v234
  v_cos_f32 v237, v236
  v_sin_f32 v238, v236
  v_cvt_pk_bf16_f32 v91, v240, v241
  v_cvt_pk_bf16_f32 v107, -v241, v240
  v_fmamk_f32 v239, v232, 0x42440000, v234
  v_cos_f32 v240, v239
  v_sin_f32 v241, v239
  v_cvt_pk_bf16_f32 v92, v237, v238
  v_cvt_pk_bf16_f32 v108, -v238, v237
  v_fmamk_f32 v236, v232, 0x42480000, v234
  v_cos_f32 v237, v236
  v_sin_f32 v238, v236
  v_cvt_pk_bf16_f32 v93, v240, v241
  v_cvt_pk_bf16_f32 v109, -v241, v240
  v_fmamk_f32 v239, v232, 0x424c0000, v234
  v_cos_f32 v240, v239
  v_sin_f32 v241, v239
  v_cvt_pk_bf16_f32 v94, v237, v238
  v_cvt_pk_bf16_f32 v110, -v238, v237
  v_fmamk_f32 v236, v233, 0x00000000, v235
  v_cvt_pk_bf16_f32 v95, v240, v241
  v_cvt_pk_bf16_f32 v111, -v241, v240
  v_cos_f32 v136, v236
  v_sin_f32 v144, v236
  v_fmamk_f32 v236, v233, 0x3f800000, v235
  v_cos_f32 v137, v236
  v_sin_f32 v145, v236
  v_fmamk_f32 v236, v233, 0x40000000, v235
  v_cos_f32 v138, v236
  v_sin_f32 v146, v236
  v_fmamk_f32 v236, v233, 0x40400000, v235
  v_cos_f32 v139, v236
  v_sin_f32 v147, v236
  v_fmamk_f32 v236, v233, 0x41800000, v235
  v_cos_f32 v140, v236
  v_sin_f32 v148, v236
  v_fmamk_f32 v236, v233, 0x41880000, v235
  v_cos_f32 v141, v236
  v_sin_f32 v149, v236
  v_fmamk_f32 v236, v233, 0x41900000, v235
  v_cos_f32 v142, v236
  v_sin_f32 v150, v236
  v_fmamk_f32 v236, v233, 0x41980000, v235
  v_cos_f32 v143, v236
  v_sin_f32 v151, v236
  v_cvt_f32_u32 v248, v12
  v_mul_f32 v232, 0x3d000000, v248
  v_mul_f32 v234, v249, v232
  v_and_b32 v248, 1, v0
  v_mul_u32_u24 v248, 0x8000, v248
  v_lshl_or_b32 v248, v248, 16, v248
  s_mov_b32 s89, 0x80008000
  v_fmamk_f32 v236, v232, 0x00000000, v234
  v_cos_f32 v216, v236
  v_sin_f32 v224, v236
  v_fmamk_f32 v236, v232, 0x3f800000, v234
  v_cos_f32 v217, v236
  v_sin_f32 v225, v236
  v_fmamk_f32 v236, v232, 0x40000000, v234
  v_cos_f32 v218, v236
  v_sin_f32 v226, v236
  v_fmamk_f32 v236, v232, 0x40400000, v234
  v_cos_f32 v219, v236
  v_sin_f32 v227, v236
  v_cvt_pk_bf16_f32 v112, v216, v217
  v_cvt_pk_bf16_f32 v113, v218, v219
  v_xor_b32 v114, v248, v112
  v_xor_b32 v115, v248, v113
  v_xor_b32 v116, 0x80000000, v112
  v_xor_b32 v117, 0x80000000, v113
  v_xor_b32 v118, 0x80000000, v114
  v_xor_b32 v119, 0x80000000, v115
  v_cvt_pk_bf16_f32 v120, v224, v225
  v_cvt_pk_bf16_f32 v121, v226, v227
  v_xor_b32 v122, v248, v120
  v_xor_b32 v123, v248, v121
  v_xor_b32 v124, 0x80000000, v120
  v_xor_b32 v125, 0x80000000, v121
  v_xor_b32 v126, 0x80000000, v122
  v_xor_b32 v127, 0x80000000, v123
  v_xor_b32 v128, s89, v120
  v_xor_b32 v129, s89, v121
  v_xor_b32 v130, s89, v122
  v_xor_b32 v131, s89, v123
  v_xor_b32 v132, s89, v124
  v_xor_b32 v133, s89, v125
  v_xor_b32 v134, s89, v126
  v_xor_b32 v135, s89, v127
  v_mul_u32_u24 v248, 1088, v13
  v_lshl_add_u32 v248, v12, 2, v248
  s_lshl_b32 s89, s49, 6
  s_add_u32 s90, s89, s83
  v_add_u32 v14, s90, v248
  v_mul_u32_u24 v248, 272, v12
  v_lshl_add_u32 v248, v13, 4, v248
  v_add_u32 v15, s83, v248
  v_lshlrev_b32 v248, 4, v12
  v_lshl_add_u32 v184, v13, 9, v248
  v_add_u32 v185, s83, v184
  v_lshlrev_b32 v248, 8, v13
  v_lshl_add_u32 v248, v12, 2, v248
  v_add_lshl_u32 v186, s89, v248, 2
  s_mul_i32 s66, s79, 8448
  s_add_u32 s67, s66, 11534336
  s_add_u32 s68, s67, 4096
  s_lshl_b32 s69, s49, 11
  s_add_u32 s69, s69, s66
  s_add_u32 s69, s69, 14680064
  s_lshr_b32 s70, s79, 6
  s_lshl_b32 s70, s70, 2
  s_and_b32 s72, s79, 3
  s_add_u32 s70, s70, s72
  s_lshl_b32 s70, s70, 8
  s_add_u32 s70, s70, 32768
  s_mov_b32 s95, 0
  s_add_u32 s66, s66, 8388608
  s_branch L_fft
R_p256:
  s_mov_b32 s63, 0x80000
SP2:
  s_mov_b32 s62, 0
  s_atomic_add s62, s[6:7], 0x9000 glc
  s_waitcnt lgkmcnt(0)
  s_cmp_ge_u32 s62, 32
  s_cbranch_scc1 SX2
  s_sub_u32 s63, s63, 1
  s_cbranch_scc1 SX2
  s_sleep 2
  s_branch SP2
SX2:
  s_branch R_p256_b
R_c7:
  s_cmp_lg_u32 s79, 0
  s_cbranch_scc1 L_nos1
  s_add_u32 s55, s67, 2162688
  s_add_u32 s56, s68, 2162688
  buffer_load_dwordx4 v[24:27], v186, s[20:23], s55 offen sc1
  buffer_load_dwordx4 v[28:31], v186, s[20:23], s56 offen sc1
  s_lshl_b32 s56, s49, 4
  v_add_u32 v1, s56, v12
  v_lshl_add_u32 v1, v13, 8, v1
  v_lshlrev_b32 v16, 2, v1
  v_sub_u32 v17, 3328, v16
  v_mov_b32 v2, s82
  s_mov_b32 s63, 0x800000
  s_mov_b64 exec, 1
W4:
  ds_read_b32 v1, v2 offset:20
  s_sub_u32 s63, s63, 1
  s_cbranch_scc1 WX4
  s_waitcnt lgkmcnt(0)
  v_cmp_gt_u32 vcc, 4, v1
  s_nop 0
  s_cbranch_vccnz W4
WX4:
  s_mov_b64 exec, -1
  v_mov_b32 v2, s82
  v_mov_b32 v1, 1
  s_mov_b64 exec, 1
  ds_add_u32 v2, v1 offset:28
  s_mov_b64 exec, -1
  s_waitcnt vmcnt(0)
  v_cmp_eq_u32 vcc, 0, v16
  ds_write_b32 v16, v192 offset:0
  ds_write_b32 v16, v24 offset:49152
  ds_write_b32 v16, v193 offset:256
  ds_write_b32 v16, v25 offset:49408
  ds_write_b32 v16, v194 offset:512
  ds_write_b32 v16, v26 offset:49664
  ds_write_b32 v16, v195 offset:768
  ds_write_b32 v16, v27 offset:49920
  ds_write_b32 v16, v196 offset:4096
  ds_write_b32 v16, v28 offset:53248
  ds_write_b32 v16, v197 offset:4352
  ds_write_b32 v16, v29 offset:53504
  ds_write_b32 v16, v198 offset:4608
  ds_write_b32 v16, v30 offset:53760
  ds_write_b32 v16, v199 offset:4864
  ds_write_b32 v16, v31 offset:54016
  s_and_saveexec_b64 s[60:61], vcc
  ds_write_b32 v16, v192 offset:8192
  ds_write_b32 v16, v24 offset:57344
  s_mov_b64 exec, s[60:61]
  s_waitcnt lgkmcnt(0)
L_nos1:
  v_mov_b32 v2, s82
  v_mov_b32 v1, 1
  s_mov_b64 exec, 1
  ds_add_u32 v2, v1 offset:28
  s_mov_b64 exec, -1
  s_branch R_c7_b
R_s2:
  ds_read_b32 v32, v17 offset:4864
  ds_read_b32 v40, v17 offset:54016
  ds_read_b32 v33, v17 offset:4608
  ds_read_b32 v41, v17 offset:53760
  ds_read_b32 v34, v17 offset:4352
  ds_read_b32 v42, v17 offset:53504
  ds_read_b32 v35, v17 offset:4096
  ds_read_b32 v43, v17 offset:53248
  ds_read_b32 v36, v17 offset:768
  ds_read_b32 v44, v17 offset:49920
  ds_read_b32 v37, v17 offset:512
  ds_read_b32 v45, v17 offset:49664
  ds_read_b32 v38, v17 offset:256
  ds_read_b32 v46, v17 offset:49408
  ds_read_b32 v39, v17 offset:0
  ds_read_b32 v47, v17 offset:49152
  s_waitcnt lgkmcnt(0)
  s_branch R_s2_b
R_s3:
  v_mov_b32 v2, s82
  s_mov_b32 s63, 0x800000
  s_mov_b64 exec, 1
W6:
  ds_read_b32 v1, v2 offset:0
  s_sub_u32 s63, s63, 1
  s_cbranch_scc1 WX6
  s_waitcnt lgkmcnt(0)
  v_cmp_gt_u32 vcc, 8, v1
  s_nop 0
  s_cbranch_vccnz W6
WX6:
  s_mov_b64 exec, -1
  v_cmp_eq_u32 vcc, 0, v16
  ds_write_b32 v16, v216 offset:0
  ds_write_b32 v16, v224 offset:49152
  ds_write_b32 v16, v217 offset:256
  ds_write_b32 v16, v225 offset:49408
  ds_write_b32 v16, v218 offset:512
  ds_write_b32 v16, v226 offset:49664
  ds_write_b32 v16, v219 offset:768
  ds_write_b32 v16, v227 offset:49920
  ds_write_b32 v16, v220 offset:4096
  ds_write_b32 v16, v228 offset:53248
  ds_write_b32 v16, v221 offset:4352
  ds_write_b32 v16, v229 offset:53504
  ds_write_b32 v16, v222 offset:4608
  ds_write_b32 v16, v230 offset:53760
  ds_write_b32 v16, v223 offset:4864
  ds_write_b32 v16, v231 offset:54016
  s_and_saveexec_b64 s[60:61], vcc
  ds_write_b32 v16, v216 offset:8192
  ds_write_b32 v16, v224 offset:57344
  s_mov_b64 exec, s[60:61]
  s_waitcnt lgkmcnt(0)
  v_mov_b32 v2, s82
  v_mov_b32 v1, 1
  s_mov_b64 exec, 1
  ds_add_u32 v2, v1 offset:32
  s_mov_b64 exec, -1
  v_lshlrev_b32 v1, 16, v32
  v_and_b32 v2, 0xffff0000, v32
  v_add_f32 v200, v200, v1
  v_sub_f32 v208, v208, v2
  v_lshlrev_b32 v1, 16, v24
  v_lshlrev_b32 v2, 16, v40
  v_add_f32 v1, v1, v2
  v_sub_f32 v48, v200, v1
  v_add_f32 v200, v200, v1
  v_and_b32 v1, 0xffff0000, v24
  v_and_b32 v2, 0xffff0000, v40
  v_sub_f32 v1, v1, v2
  v_sub_f32 v56, v208, v1
  v_add_f32 v208, v208, v1
  v_lshlrev_b32 v1, 16, v33
  v_and_b32 v2, 0xffff0000, v33
  v_add_f32 v201, v201, v1
  v_sub_f32 v209, v209, v2
  v_lshlrev_b32 v1, 16, v25
  v_lshlrev_b32 v2, 16, v41
  v_add_f32 v1, v1, v2
  v_sub_f32 v49, v201, v1
  v_add_f32 v201, v201, v1
  v_and_b32 v1, 0xffff0000, v25
  v_and_b32 v2, 0xffff0000, v41
  v_sub_f32 v1, v1, v2
  v_sub_f32 v57, v209, v1
  v_add_f32 v209, v209, v1
  v_lshlrev_b32 v1, 16, v34
  v_and_b32 v2, 0xffff0000, v34
  v_add_f32 v202, v202, v1
  v_sub_f32 v210, v210, v2
  v_lshlrev_b32 v1, 16, v26
  v_lshlrev_b32 v2, 16, v42
  v_add_f32 v1, v1, v2
  v_sub_f32 v50, v202, v1
  v_add_f32 v202, v202, v1
  v_and_b32 v1, 0xffff0000, v26
  v_and_b32 v2, 0xffff0000, v42
  v_sub_f32 v1, v1, v2
  v_sub_f32 v58, v210, v1
  v_add_f32 v210, v210, v1
  v_lshlrev_b32 v1, 16, v35
  v_and_b32 v2, 0xffff0000, v35
  v_add_f32 v203, v203, v1
  v_sub_f32 v211, v211, v2
  v_lshlrev_b32 v1, 16, v27
  v_lshlrev_b32 v2, 16, v43
  v_add_f32 v1, v1, v2
  v_sub_f32 v51, v203, v1
  v_add_f32 v203, v203, v1
  v_and_b32 v1, 0xffff0000, v27
  v_and_b32 v2, 0xffff0000, v43
  v_sub_f32 v1, v1, v2
  v_sub_f32 v59, v211, v1
  v_add_f32 v211, v211, v1
  v_lshlrev_b32 v1, 16, v36
  v_and_b32 v2, 0xffff0000, v36
  v_add_f32 v204, v204, v1
  v_sub_f32 v212, v212, v2
  v_lshlrev_b32 v1, 16, v28
  v_lshlrev_b32 v2, 16, v44
  v_add_f32 v1, v1, v2
  v_sub_f32 v52, v204, v1
  v_add_f32 v204, v204, v1
  v_and_b32 v1, 0xffff0000, v28
  v_and_b32 v2, 0xffff0000, v44
  v_sub_f32 v1, v1, v2
  v_sub_f32 v60, v212, v1
  v_add_f32 v212, v212, v1
  v_lshlrev_b32 v1, 16, v37
  v_and_b32 v2, 0xffff0000, v37
  v_add_f32 v205, v205, v1
  v_sub_f32 v213, v213, v2
  v_lshlrev_b32 v1, 16, v29
  v_lshlrev_b32 v2, 16, v45
  v_add_f32 v1, v1, v2
  v_sub_f32 v53, v205, v1
  v_add_f32 v205, v205, v1
  v_and_b32 v1, 0xffff0000, v29
  v_and_b32 v2, 0xffff0000, v45
  v_sub_f32 v1, v1, v2
  v_sub_f32 v61, v213, v1
  v_add_f32 v213, v213, v1
  v_lshlrev_b32 v1, 16, v38
  v_and_b32 v2, 0xffff0000, v38
  v_add_f32 v206, v206, v1
  v_sub_f32 v214, v214, v2
  v_lshlrev_b32 v1, 16, v30
  v_lshlrev_b32 v2, 16, v46
  v_add_f32 v1, v1, v2
  v_sub_f32 v54, v206, v1
  v_add_f32 v206, v206, v1
  v_and_b32 v1, 0xffff0000, v30
  v_and_b32 v2, 0xffff0000, v46
  v_sub_f32 v1, v1, v2
  v_sub_f32 v62, v214, v1
  v_add_f32 v214, v214, v1
  v_lshlrev_b32 v1, 16, v39
  v_and_b32 v2, 0xffff0000, v39
  v_add_f32 v207, v207, v1
  v_sub_f32 v215, v215, v2
  v_lshlrev_b32 v1, 16, v31
  v_lshlrev_b32 v2, 16, v47
  v_add_f32 v1, v1, v2
  v_sub_f32 v55, v207, v1
  v_add_f32 v207, v207, v1
  v_and_b32 v1, 0xffff0000, v31
  v_and_b32 v2, 0xffff0000, v47
  v_sub_f32 v1, v1, v2
  v_sub_f32 v63, v215, v1
  v_add_f32 v215, v215, v1
  v_mul_f32 v232, v216, v200
  v_mul_f32 v240, v224, v200
  v_fma_f32 v232, -v224, v208, v232
  v_fmac_f32 v240, v216, v208
  v_mul_f32 v233, v217, v201
  v_mul_f32 v241, v225, v201
  v_fma_f32 v233, -v225, v209, v233
  v_fmac_f32 v241, v217, v209
  v_mul_f32 v234, v218, v202
  v_mul_f32 v242, v226, v202
  v_fma_f32 v234, -v226, v210, v234
  v_fmac_f32 v242, v218, v210
  v_mul_f32 v235, v219, v203
  v_mul_f32 v243, v227, v203
  v_fma_f32 v235, -v227, v211, v235
  v_fmac_f32 v243, v219, v211
  v_mul_f32 v236, v220, v204
  v_mul_f32 v244, v228, v204
  v_fma_f32 v236, -v228, v212, v236
  v_fmac_f32 v244, v220, v212
  v_mul_f32 v237, v221, v205
  v_mul_f32 v245, v229, v205
  v_fma_f32 v237, -v229, v213, v237
  v_fmac_f32 v245, v221, v213
  v_mul_f32 v238, v222, v206
  v_mul_f32 v246, v230, v206
  v_fma_f32 v238, -v230, v214, v238
  v_fmac_f32 v246, v222, v214
  v_mul_f32 v239, v223, v207
  v_mul_f32 v247, v231, v207
  v_fma_f32 v239, -v231, v215, v239
  v_fmac_f32 v247, v223, v215
  v_mov_b32 v2, s82
  s_mov_b32 s63, 0x800000
  s_mov_b64 exec, 1
W7:
  ds_read_b32 v1, v2 offset:32
  s_sub_u32 s63, s63, 1
  s_cbranch_scc1 WX7
  s_waitcnt lgkmcnt(0)
  v_cmp_gt_u32 vcc, 4, v1
  s_nop 0
  s_cbranch_vccnz W7
WX7:
  s_mov_b64 exec, -1
  ds_read_b32 v64, v17 offset:4864
  ds_read_b32 v72, v17 offset:54016
  ds_read_b32 v65, v17 offset:4608
  ds_read_b32 v73, v17 offset:53760
  ds_read_b32 v66, v17 offset:4352
  ds_read_b32 v74, v17 offset:53504
  ds_read_b32 v67, v17 offset:4096
  ds_read_b32 v75, v17 offset:53248
  ds_read_b32 v68, v17 offset:768
  ds_read_b32 v76, v17 offset:49920
  ds_read_b32 v69, v17 offset:512
  ds_read_b32 v77, v17 offset:49664
  ds_read_b32 v70, v17 offset:256
  ds_read_b32 v78, v17 offset:49408
  ds_read_b32 v71, v17 offset:0
  ds_read_b32 v79, v17 offset:49152
  s_waitcnt lgkmcnt(0)
  v_fmac_f32 v232, v64, v48
  v_fmac_f32 v240, v64, v56
  v_fmac_f32 v232, v72, v56
  v_fma_f32 v240, -v72, v48, v240
  v_fmac_f32 v233, v65, v49
  v_fmac_f32 v241, v65, v57
  v_fmac_f32 v233, v73, v57
  v_fma_f32 v241, -v73, v49, v241
  v_fmac_f32 v234, v66, v50
  v_fmac_f32 v242, v66, v58
  v_fmac_f32 v234, v74, v58
  v_fma_f32 v242, -v74, v50, v242
  v_fmac_f32 v235, v67, v51
  v_fmac_f32 v243, v67, v59
  v_fmac_f32 v235, v75, v59
  v_fma_f32 v243, -v75, v51, v243
  v_fmac_f32 v236, v68, v52
  v_fmac_f32 v244, v68, v60
  v_fmac_f32 v236, v76, v60
  v_fma_f32 v244, -v76, v52, v244
  v_fmac_f32 v237, v69, v53
  v_fmac_f32 v245, v69, v61
  v_fmac_f32 v237, v77, v61
  v_fma_f32 v245, -v77, v53, v245
  v_fmac_f32 v238, v70, v54
  v_fmac_f32 v246, v70, v62
  v_fmac_f32 v238, v78, v62
  v_fma_f32 v246, -v78, v54, v246
  v_fmac_f32 v239, v71, v55
  v_fmac_f32 v247, v71, v63
  v_fmac_f32 v239, v79, v63
  v_fma_f32 v247, -v79, v55, v247
  v_cvt_pk_bf16_f32 v248, v232, v233
  v_cvt_pk_bf16_f32 v249, v234, v235
  v_cvt_pk_bf16_f32 v250, v236, v237
  v_cvt_pk_bf16_f32 v251, v238, v239
  v_cvt_pk_bf16_f32 v252, v240, v241
  v_cvt_pk_bf16_f32 v253, v242, v243
  v_cvt_pk_bf16_f32 v254, v244, v245
  v_cvt_pk_bf16_f32 v255, v246, v247
  s_branch L_s3
R_own:
  s_mov_b32 s63, 0x80000
SP17:
  s_mov_b32 s62, 0
  s_atomic_add s62, s[6:7], s70 glc
  s_waitcnt lgkmcnt(0)
  s_cmp_ge_u32 s62, 7
  s_cbranch_scc1 SX17
  s_sub_u32 s63, s63, 1
  s_cbranch_scc1 SX17
  s_sleep 2
  s_branch SP17
SX17:
  s_add_u32 s60, s85, 0
  s_sub_u32 s92, s60, 7
  s_cselect_b32 s60, s60, s92
  s_lshl_b32 s60, s60, 14
  buffer_load_dwordx4 v[128:131], v184, s[20:23], s60 offen offset:0 sc1
  buffer_load_dwordx4 v[132:135], v184, s[20:23], s60 offen offset:1024 sc1
  buffer_load_dwordx4 v[136:139], v184, s[20:23], s60 offen offset:2048 sc1
  buffer_load_dwordx4 v[140:143], v184, s[20:23], s60 offen offset:3072 sc1
  s_add_u32 s60, s85, 0
  s_sub_u32 s92, s60, 7
  s_cselect_b32 s60, s60, s92
  s_lshl_b32 s60, s60, 14
  buffer_load_dwordx4 v[160:163], v185, s[20:23], s60 offen offset:0 sc1
  buffer_load_dwordx4 v[164:167], v185, s[20:23], s60 offen offset:1024 sc1
  buffer_load_dwordx4 v[168:171], v185, s[20:23], s60 offen offset:2048 sc1
  buffer_load_dwordx4 v[172:175], v185, s[20:23], s60 offen offset:3072 sc1
  s_add_u32 s60, s85, 1
  s_sub_u32 s92, s60, 7
  s_cselect_b32 s60, s60, s92
  s_lshl_b32 s60, s60, 14
  buffer_load_dwordx4 v[144:147], v184, s[20:23], s60 offen offset:0 sc1
  buffer_load_dwordx4 v[148:151], v184, s[20:23], s60 offen offset:1024 sc1
  buffer_load_dwordx4 v[152:155], v184, s[20:23], s60 offen offset:2048 sc1
  buffer_load_dwordx4 v[156:159], v184, s[20:23], s60 offen offset:3072 sc1
  s_waitcnt vmcnt(11)
  v_mfma_f32_16x16x32_bf16 v[192:195], v[16:19], v[128:131], 0
  v_mfma_f32_16x16x32_bf16 v[208:211], v[20:23], v[128:131], 0
  v_mfma_f32_16x16x32_bf16 v[224:227], v[24:27], v[128:131], 0
  v_mfma_f32_16x16x32_bf16 v[240:243], v[28:31], v[128:131], 0
  s_add_u32 s60, s85, 2
  s_sub_u32 s92, s60, 7
  s_cselect_b32 s60, s60, s92
  s_lshl_b32 s60, s60, 14
  buffer_load_dwordx4 v[128:131], v184, s[20:23], s60 offen offset:0 sc1
  s_waitcnt vmcnt(11)
  v_mfma_f32_16x16x32_bf16 v[196:199], v[16:19], v[132:135], 0
  v_mfma_f32_16x16x32_bf16 v[212:215], v[20:23], v[132:135], 0
  v_mfma_f32_16x16x32_bf16 v[228:231], v[24:27], v[132:135], 0
  v_mfma_f32_16x16x32_bf16 v[244:247], v[28:31], v[132:135], 0
  buffer_load_dwordx4 v[132:135], v184, s[20:23], s60 offen offset:1024 sc1
  s_waitcnt vmcnt(11)
  v_mfma_f32_16x16x32_bf16 v[200:203], v[16:19], v[136:139], 0
  v_mfma_f32_16x16x32_bf16 v[216:219], v[20:23], v[136:139], 0
  v_mfma_f32_16x16x32_bf16 v[232:235], v[24:27], v[136:139], 0
  v_mfma_f32_16x16x32_bf16 v[248:251], v[28:31], v[136:139], 0
  buffer_load_dwordx4 v[136:139], v184, s[20:23], s60 offen offset:2048 sc1
  s_waitcnt vmcnt(11)
  v_mfma_f32_16x16x32_bf16 v[204:207], v[16:19], v[140:143], 0
  v_mfma_f32_16x16x32_bf16 v[220:223], v[20:23], v[140:143], 0
  v_mfma_f32_16x16x32_bf16 v[236:239], v[24:27], v[140:143], 0
  v_mfma_f32_16x16x32_bf16 v[252:255], v[28:31], v[140:143], 0
  buffer_load_dwordx4 v[140:143], v184, s[20:23], s60 offen offset:3072 sc1
  s_branch L_own
L_end:
  s_endpgm
  .space 1536
.section .rodata,"a"
.p2align 6
.amdhsa_kernel gated_mix__spectral_gfnet__glu_gated_reglu__prompt_kernel
  .amdhsa_next_free_vgpr 256
  .amdhsa_next_free_sgpr 102
  .amdhsa_accum_offset 256
  .amdhsa_group_segment_fixed_size 0
  .amdhsa_kernarg_size 88
  .amdhsa_user_sgpr_count 2
  .amdhsa_user_sgpr_kernarg_segment_ptr 1
  .amdhsa_system_sgpr_workgroup_id_x 1
.end_amdhsa_kernel
```
